```python
import torch

def _softmax(x, axis=-1):
    return torch.softmax(x, dim=axis)
def _gelu(x):
    return torch.nn.functional.gelu(x, approximate="tanh")
def _silu(x):
    return torch.nn.functional.silu(x)
def _sigmoid(x):
    return torch.sigmoid(x)
def _layernorm(x, axis=-1, eps=1e-5):
    m = x.mean(dim=axis, keepdim=True)
    v = x.var(dim=axis, keepdim=True, unbiased=False)
    return (x - m) / torch.sqrt(v + eps)
def _scatter_add(tgt, idx, src, axis=0):
    return tgt.clone().index_add_(axis, idx, src)
def _segment_sum(src, seg, n):
    out = torch.zeros((n,) + src.shape[1:], dtype=src.dtype)
    return out.index_add_(0, seg, src)
def _pad(x, pw):
    flat = tuple(v for pair in reversed(pw) for v in pair)
    return torch.nn.functional.pad(x, flat)

kernel_name = 'parallel_sum__mha_block_cached__mixer_token_mlp__decode'

def setup_inputs():

    _w = (lambda a: (lambda t: t.to(torch.bfloat16) if t.is_floating_point() else t)(torch.as_tensor(a)))
    def _A_setup():
        B, Sq, D = 8, 1, 512
        H, Sk, Dh = 32, 4096, 128
        return {
            "x": _w((lambda *s: torch.randn(*s, dtype=torch.bfloat16) * 0.05)(B, Sq, D)),
            "k_cache": _w((lambda *s: torch.randn(*s, dtype=torch.bfloat16) * 3.2)(B, H, Sk, Dh)),
            "v_cache": _w((lambda *s: torch.randn(*s, dtype=torch.bfloat16) * 0.8)(B, H, Sk, Dh)),
            "wq": _w((lambda *s: torch.randn(*s, dtype=torch.bfloat16) * 3.2)(D, H * Dh) * (D ** -0.5)),
            "wo": _w((lambda *s: torch.randn(*s, dtype=torch.bfloat16) * 0.8)(H * Dh, D) * ((H * Dh) ** -0.5)),
        }
    _A_in = _A_setup()

    def _B_setup():
        B, S, D, F = 8, 1, 512, 1792
        return {
            "x": _w((lambda *s: torch.randn(*s, dtype=torch.bfloat16) * 0.05)(B, S, D)),
            "w1": _w((lambda *s: torch.randn(*s, dtype=torch.bfloat16) * 3.2)(S, F) * (S ** -0.5)),
            "b1": _w((lambda *s: torch.randn(*s, dtype=torch.bfloat16) * 3.2)(F) * 0.02),
            "w2": _w((lambda *s: torch.randn(*s, dtype=torch.bfloat16) * 0.8)(F, S) * (F ** -0.5)),
            "b2": _w((lambda *s: torch.randn(*s, dtype=torch.bfloat16) * 0.8)(S) * 0.02),
        }
    _B_in = _B_setup()

    return {
        "A_x": _A_in["x"],
        "A_k_cache": _A_in["k_cache"],
        "A_v_cache": _A_in["v_cache"],
        "A_wq": _A_in["wq"],
        "A_wo": _A_in["wo"],
        "B_x": _B_in["x"],
        "B_w1": _B_in["w1"],
        "B_b1": _B_in["b1"],
        "B_w2": _B_in["w2"],
        "B_b2": _B_in["b2"],
    }

def reference(A_x, A_k_cache, A_v_cache, A_wq, A_wo, B_x, B_w1, B_b1, B_w2, B_b2):
    def _A_ref(x, k_cache, v_cache, wq, wo):
        B, Sq, D = x.shape
        H, Dh = 32, 128
        q = (lambda x, *d: x.permute(*d))((x @ wq).reshape(B, Sq, H, Dh), 0, 2, 1, 3)
        scores = torch.einsum("bhqd,bhkd->bhqk", q, k_cache) * (Dh ** -0.5)
        p = _softmax(scores, axis=-1)
        o = torch.einsum("bhqk,bhkd->bhqd", p, v_cache)
        return (lambda x, *d: x.permute(*d))(o, 0, 2, 1, 3).reshape(B, Sq, H * Dh) @ wo

    def _B_ref(x, w1, b1, w2, b2):
        B, S, D = x.shape
        h = _layernorm(x, axis=-1)
        u = torch.einsum("bsd,sf->bdf", h, w1) + b1
        u = _gelu(u)
        y = torch.einsum("bdf,fs->bds", u, w2) + b2
        return (lambda x, *d: x.permute(*d))(y, 0, 2, 1)

    x = A_x
    xn = _layernorm(x, axis=-1)
    return x + _A_ref(xn, A_k_cache, A_v_cache, A_wq, A_wo) + _B_ref(xn, B_w1, B_b1, B_w2, B_b2)
```

```asm
; @launch grid=(256,1,1) block=(576,1,1) lds=153728
.amdgcn_target "amdgcn-amd-amdhsa--gfx950"
.text
.globl parallel_sum__mha_block_cached__mixer_token_mlp__decode_kernel
.p2align 8
.type parallel_sum__mha_block_cached__mixer_token_mlp__decode_kernel,@function
parallel_sum__mha_block_cached__mixer_token_mlp__decode_kernel:
    s_cmpk_ge_u32 s2, 256
    s_cbranch_scc1 L_end
    s_load_dwordx16 s[4:19], s[0:1], 0
    s_load_dwordx8 s[20:27], s[0:1], 64
    s_load_dwordx2 s[28:29], s[0:1], 96
    v_readfirstlane_b32 s32, v0
    v_and_b32 v0, 63, v0
    v_lshrrev_b32 v1, 4, v0
    v_and_b32 v2, 15, v0
    s_mov_b32 s39, 0x20000
    s_lshr_b32 s32, s32, 6
    s_cbranch_scc1 L_cons
    v_xor_b32 v4, v2, v1
    v_lshlrev_b32 v4, 4, v4
    v_lshl_add_u32 v4, v1, 8, v4
    v_xor_b32 v5, 64, v4
    v_xor_b32 v6, 0x80, v4
    v_xor_b32 v7, 64, v6
    s_lshl_b32 s38, 1, 20
    s_lshl_b32 s44, s2, 20
    s_and_b32 s51, s2, 40
    s_mulk_i32 s51, 0x600
    s_and_b32 s51, s51, 0x6000
    s_mov_b32 s33, 0
    s_mov_b32 m0, 0
    s_lshl_b32 s41, 1, 12
    s_lshl_b32 s42, 1, 13
    s_waitcnt lgkmcnt(0)
    s_add_u32 s36, s6, s44
    s_addc_u32 s37, s7, 0
L_l0:
    s_xor_b32 s50, s33, s51
    buffer_load_dwordx4 v4, s[36:39], s50 offen offset:0 nt lds
    buffer_load_dwordx4 v5, s[36:39], s50 offen offset:1024 nt lds
    buffer_load_dwordx4 v6, s[36:39], s50 offen offset:2048 nt lds
    buffer_load_dwordx4 v7, s[36:39], s50 offen offset:3072 nt lds
    s_addk_i32 m0, 4096
    s_bitset1_b32 s50, 15
    buffer_load_dwordx4 v4, s[36:39], s50 offen offset:0 nt lds
    buffer_load_dwordx4 v5, s[36:39], s50 offen offset:1024 nt lds
    buffer_load_dwordx4 v6, s[36:39], s50 offen offset:2048 nt lds
    buffer_load_dwordx4 v7, s[36:39], s50 offen offset:3072 nt lds
    s_addk_i32 m0, 4096
    s_xor_b32 s33, s33, s41
    s_xor_b32 s41, s41, s42
    s_cmpk_lg_u32 m0, 24576
    s_cbranch_scc1 L_l0
    s_barrier
    s_setprio 3
    s_xor_b32 s50, s33, s51
    v_mov_b32 v3, 153344
    v_mov_b32 v8, -1
    v_mov_b32 v10, 0
    s_mov_b32 s32, -1
L_ls:
    s_waitcnt vmcnt(25)
    buffer_load_dwordx4 v4, s[36:39], s50 offen offset:0 nt lds
    s_waitcnt vmcnt(25)
    buffer_load_dwordx4 v5, s[36:39], s50 offen offset:1024 nt lds
    v_add_u32 v8, 1, v8
    ds_write_b32 v3, v8
    s_xor_b32 s33, s33, s41
    s_waitcnt vmcnt(25)
    buffer_load_dwordx4 v6, s[36:39], s50 offen offset:2048 nt lds
    s_xor_b32 s41, s41, s42
    s_waitcnt vmcnt(25)
    buffer_load_dwordx4 v7, s[36:39], s50 offen offset:3072 nt lds
    s_addk_i32 m0, 4096
    s_bitset1_b32 s50, 15
    s_waitcnt vmcnt(25)
    buffer_load_dwordx4 v4, s[36:39], s50 offen offset:0 nt lds
    s_waitcnt vmcnt(25)
    buffer_load_dwordx4 v5, s[36:39], s50 offen offset:1024 nt lds
    v_add_u32 v8, 1, v8
    ds_write_b32 v3, v8
    s_waitcnt vmcnt(25)
    buffer_load_dwordx4 v6, s[36:39], s50 offen offset:2048 nt lds
    s_waitcnt vmcnt(25)
    buffer_load_dwordx4 v7, s[36:39], s50 offen offset:3072 nt lds
    s_addk_i32 m0, 4096
    s_xor_b32 s50, s33, s51
    s_and_b32 s49, m0, 0x7fff
    s_cbranch_scc1 L_ls
    s_bfe_u32 s49, m0, 0x4000f
    s_lshl_b32 s33, s49, 16
    s_bfe_u32 s49, m0, 0x10013
    s_lshl_b32 s49, s49, 14
    s_or_b32 s33, s33, s49
    s_xor_b32 s50, s33, s51
    s_cmp_lg_u32 m0, 131072
    s_cbranch_scc1 L_ls
    v_mov_b32 v8, 25
    s_mov_b32 s34, 3
    s_add_u32 s8, s8, s44
    s_addc_u32 s9, s9, 0
    s_mov_b32 s54, 0x4000000
    v_min_u32 v9, 8, v0
    v_lshl_add_u32 v9, v9, 2, v3
    v_mov_b32 v11, 0
    v_cmp_lt_u32 vcc, 7, v0
    v_mov_b32 v14, 165
    v_mov_b32 v15, -1000
    ds_write_b32 v3, v14 offset:64
    s_mov_b32 s46, 0
    v_cndmask_b32 v11, v11, v15, vcc
    v_cndmask_b32 v10, v10, v14, vcc
    s_branch L_ld1
L_ld:
    s_add_u32 s46, s46, s47
    s_cbranch_scc0 L_ndm00
    buffer_load_dword v12, v4, s[36:39], s38 offen
L_ndm00:
    s_waitcnt vmcnt(25)
    buffer_load_dwordx4 v4, s[36:39], s50 offen offset:0 nt lds
    s_waitcnt vmcnt(25)
    buffer_load_dwordx4 v5, s[36:39], s50 offen offset:1024 nt lds
    v_add_u32 v8, 1, v8
    ds_write_b32 v3, v8
    s_xor_b32 s33, s33, s41
    s_add_u32 s46, s46, s47
    s_cbranch_scc0 L_ndm02
    buffer_load_dword v12, v4, s[36:39], s38 offen
L_ndm02:
    s_waitcnt vmcnt(25)
    buffer_load_dwordx4 v6, s[36:39], s50 offen offset:2048 nt lds
    s_xor_b32 s41, s41, s42
    s_waitcnt vmcnt(25)
    buffer_load_dwordx4 v7, s[36:39], s50 offen offset:3072 nt lds
    s_addk_i32 m0, 4096
    s_bitset1_b32 s50, 15
    s_add_u32 s46, s46, s47
    s_cbranch_scc0 L_ndm10
    buffer_load_dword v12, v4, s[36:39], s38 offen
L_ndm10:
    s_waitcnt vmcnt(25)
    buffer_load_dwordx4 v4, s[36:39], s50 offen offset:0 nt lds
    ds_read_b32 v10, v9 offset:32
    s_waitcnt vmcnt(25)
    buffer_load_dwordx4 v5, s[36:39], s50 offen offset:1024 nt lds
    v_add_u32 v8, 1, v8
    ds_write_b32 v3, v8
    s_add_u32 s46, s46, s47
    s_cbranch_scc0 L_ndm12
    buffer_load_dword v12, v4, s[36:39], s38 offen
L_ndm12:
    s_waitcnt vmcnt(25)
    buffer_load_dwordx4 v6, s[36:39], s50 offen offset:2048 nt lds
    s_waitcnt vmcnt(25)
    buffer_load_dwordx4 v7, s[36:39], s50 offen offset:3072 nt lds
    s_addk_i32 m0, 4096
    s_xor_b32 s50, s33, s51
    s_sub_u32 s40, s40, 1
    s_cbranch_scc0 L_ld
L_ld1:
    s_bitset0_b32 m0, 17
    s_add_u32 s34, s34, 1
    v_add_u32 v11, 1, v11
    s_bfe_u32 s49, s34, 0x40000
    s_lshl_b32 s33, s49, 16
    s_bfe_u32 s49, s34, 0x10004
    s_lshl_b32 s49, s49, 14
    s_or_b32 s33, s33, s49
    s_xor_b32 s50, s33, s51
    s_and_b32 s40, s34, 31
    s_cbranch_scc0 L_ldsw
L_ldck:
    s_waitcnt lgkmcnt(0)
    v_cmp_lt_i32 vcc, v10, v11
    s_cbranch_vccnz L_ldslow
    s_mov_b32 s40, 3
    v_readlane_b32 s47, v10, 8
    s_lshl_b32 s47, s47, 24
    s_branch L_ld
L_ldslow:
    ds_read_b32 v10, v9 offset:32
    s_branch L_ldck
L_ldsw:
    s_cmp_eq_u32 s34, 64
    s_cbranch_scc1 L_drain
    s_mov_b32 s36, s8
    s_mov_b32 s37, s9
    s_mov_b32 s33, 0
    s_mov_b32 s50, s51
    v_lshlrev_b32 v4, 4, v0
    v_lshlrev_b32 v5, 4, v0
    v_lshlrev_b32 v6, 4, v0
    v_lshlrev_b32 v7, 4, v0
    s_branch L_ldck
L_drain:
    v_and_b32 v21, 7, v0
    v_lshrrev_b32 v22, 5, v0
    v_lshl_add_u32 v21, v21, 1, v22
    v_lshl_add_u32 v22, v21, 2, v3
    ds_read_b32 v17, v3 offset:12
    ds_read_b32 v18, v22 offset:256
    ds_read_b32 v19, v22 offset:320
    s_lshl_b32 s44, s2, 5
    v_lshl_add_u32 v20, v21, 1, s44
    s_lshr_b32 s45, s2, 1
    s_xor_b32 s45, s45, s2
    s_and_b32 s45, s45, 2
    s_mul_i32 s45, s45, 3
    s_xor_b32 s45, s45, s2
    s_lshl_b32 s44, s45, 12
    ds_read_b32 v23, v3 offset:20
    s_and_b32 s45, s44, 0x2000
    s_bitset0_b32 s44, 13
    v_add_u32 v4, s45, v4
    s_add_u32 s56, s28, s44
    s_addc_u32 s57, s29, 0
    s_movk_i32 s58, 12288
    s_mov_b32 s59, 0x20000
    s_waitcnt lgkmcnt(0)
    v_xor_b32 v4, v23, v4
    s_mov_b32 s52, 0xffff0000
    s_mov_b64 s[44:45], -1
    s_mov_b64 s[46:47], -1
    s_waitcnt vmcnt(24)
    v_add_u32 v8, 1, v8
    ds_write_b32 v3, v8
    s_waitcnt vmcnt(20)
    v_add_u32 v8, 1, v8
    ds_write_b32 v3, v8
    s_waitcnt vmcnt(16)
    v_add_u32 v8, 1, v8
    ds_write_b32 v3, v8
    s_waitcnt vmcnt(12)
    v_add_u32 v8, 1, v8
    ds_write_b32 v3, v8
    s_waitcnt vmcnt(8)
    v_add_u32 v8, 1, v8
    ds_write_b32 v3, v8
    s_waitcnt vmcnt(4)
    v_add_u32 v8, 1, v8
    ds_write_b32 v3, v8
    s_waitcnt vmcnt(0)
    v_add_u32 v8, 1, v8
    ds_write_b32 v3, v8
    s_cbranch_execz L_fin0
    buffer_load_dwordx4 v[32:35], v4, s[56:59], 0 offen offset:0 sc1
    buffer_load_dwordx4 v[36:39], v4, s[56:59], 0 offen offset:1024 sc1
    buffer_load_dwordx4 v[40:43], v4, s[56:59], 0 offen offset:2048 sc1
    buffer_load_dwordx4 v[44:47], v4, s[56:59], 0 offen offset:3072 sc1
    s_waitcnt lgkmcnt(0)
    s_barrier
L_poll:
    s_waitcnt vmcnt(0)
    s_mov_b64 exec, s[44:45]
    v_cmpx_eq_u32 vcc, v17, v33
    v_cmpx_eq_u32 vcc, v17, v35
    v_cmpx_eq_u32 vcc, v17, v37
    v_cmpx_eq_u32 vcc, v17, v39
    v_cmpx_eq_u32 vcc, v17, v41
    v_cmpx_eq_u32 vcc, v17, v43
    v_cmpx_eq_u32 vcc, v17, v45
    v_cmpx_eq_u32 vcc, v17, v47
    s_andn2_b64 s[44:45], s[44:45], exec
    s_cbranch_scc0 L_got0
    s_mov_b64 exec, s[44:45]
    buffer_load_dwordx4 v[32:35], v4, s[56:59], 0 offen offset:0 sc1
    buffer_load_dwordx4 v[36:39], v4, s[56:59], 0 offen offset:1024 sc1
    buffer_load_dwordx4 v[40:43], v4, s[56:59], 0 offen offset:2048 sc1
    buffer_load_dwordx4 v[44:47], v4, s[56:59], 0 offen offset:3072 sc1
    s_sub_u32 s54, s54, 16
    s_cbranch_scc0 L_poll
    s_endpgm
L_got0:
    s_mov_b64 exec, -1
L_fin0:
    v_add_f32 v24, v32, v40
    v_add_f32 v25, v34, v42
    v_add_f32 v26, v36, v44
    v_add_f32 v27, v38, v46
L_fin1:
    v_add_f32 v24, v24, v26
    v_add_f32 v25, v25, v27
    s_nop 1
    v_permlane32_swap_b32 v24, v25
    v_add_f32 v24, v24, v25
    v_mov_b32 v25, v24
    s_nop 1
    v_permlane16_swap_b32 v24, v25
    v_add_f32 v24, v24, v25
    s_nop 1
    v_add_f32_dpp v24, v24, v24 row_ror:8 row_mask:0xf bank_mask:0xf
    v_cvt_pk_bf16_f32 v24, v24, v24
    v_and_b32 v24, s52, v24
    v_add_f32 v24, v18, v24
    v_cvt_pk_bf16_f32 v24, v24, v24
    v_and_b32 v24, s52, v24
    v_add_f32 v24, v24, v19
    v_cvt_pk_bf16_f32 v24, v24, v24
    s_cbranch_execz L_dryret
    s_mov_b32 exec_lo, 0xff
    s_mov_b32 exec_hi, 0xff
    global_store_short v20, v24, s[24:25] sc1
    s_and_b32 s44, s2, 31
    s_cbranch_scc1 L_fin
    s_lshl_b32 s44, s2, 3
    s_add_u32 s44, s44, 0x180000
    v_mov_b32 v16, s44
    s_mov_b64 exec, 1
    global_store_dword v16, v17, s[28:29] sc1
    s_branch L_fin
L_cons:
    s_getpc_b64 s[46:47]
L_pc:
    s_sub_u32 s46, s46, L_pc-L_ls+2048
    s_subb_u32 s47, s47, 0
    s_lshl_b32 s44, s32, 11
    v_lshl_add_u32 v9, v0, 5, s44
    v_min_u32 v9, L_end-L_ls+2048, v9
    global_load_dword v16, v9, s[46:47]
L_nipf:
    v_mov_b32 v3, 153344
    v_lshl_add_u32 v9, v0, 2, v3
    v_mov_b32 v10, 0
    ds_write_b32 v9, v10
    s_sub_u32 s32, s32, 1
    s_lshr_b32 s30, s2, 5
    s_and_b32 s31, s2, 31
    s_mov_b32 s52, 0xffff0000
    s_mov_b32 s59, 0x20000
    s_lshl_b32 s44, s30, 10
    v_lshlrev_b32 v8, 4, v0
    s_waitcnt lgkmcnt(0)
    s_add_u32 s4, s4, s44
    s_addc_u32 s5, s5, 0
    global_load_dwordx4 v[4:7], v8, s[4:5]
    s_lshl_b32 s44, s32, 19
    s_lshl_b32 s45, s31, 8
    s_add_u32 s44, s44, s45
    s_add_u32 s36, s10, s44
    s_addc_u32 s37, s11, 0
    s_sub_u32 s38, 0x400000, s44
    v_lshlrev_b32 v9, 14, v1
    v_lshl_add_u32 v9, v2, 4, v9
    s_lshl_b32 s46, s32, 16
    s_mov_b32 s48, 0x180000
    s_load_dword s78, s[28:29], s48
    s_lshl_b32 s49, s31, 17
    s_lshl_b32 s50, s32, 10
    s_add_u32 s49, s49, s50
    s_and_b32 s50, s30, 4
    s_add_u32 s50, s50, s30
    s_lshl_b32 s50, s50, 13
    s_add_u32 s49, s49, s50
    s_lshl_b32 s51, s30, 3
    s_add_u32 s51, s51, s32
    s_cmp_lg_u32 s51, 7
    s_cbranch_scc1 L_nsw
    v_min_u32 v10, 55, v0
    v_lshlrev_b32 v10, 6, v10
    global_load_dword v17, v10, s[16:17]
    global_load_dword v18, v10, s[18:19]
    global_load_dword v19, v10, s[20:21]
    v_mov_b32 v10, 0
    global_load_ushort v20, v10, s[22:23]
    v_and_b32 v10, 7, v0
    v_lshlrev_b32 v10, 8, v10
    v_add_u32 v10, 0x180000, v10
    global_load_dword v21, v10, s[28:29]
L_nsw:
    v_add_u32 v11, s49, v8
    s_barrier
    global_load_dwordx4 v[160:163], v11, s[12:13]
    v_add_u32 v11, 0x8000, v11
    global_load_dwordx4 v[164:167], v11, s[12:13]
    s_xor_b32 s47, s46, 0
    buffer_load_dwordx4 v[64:67], v9, s[36:39], s47 offen
    s_xor_b32 s47, s46, 8192
    buffer_load_dwordx4 v[68:71], v9, s[36:39], s47 offen
    s_xor_b32 s47, s46, 65536
    buffer_load_dwordx4 v[72:75], v9, s[36:39], s47 offen
    s_xor_b32 s47, s46, 73728
    buffer_load_dwordx4 v[76:79], v9, s[36:39], s47 offen
    s_waitcnt vmcnt(6)
    v_lshlrev_b32 v16, 16, v4
    v_and_b32 v17, s52, v4
    v_lshlrev_b32 v18, 16, v5
    v_and_b32 v19, s52, v5
    v_lshlrev_b32 v20, 16, v6
    v_and_b32 v21, s52, v6
    v_lshlrev_b32 v22, 16, v7
    v_and_b32 v23, s52, v7
    v_add_f32 v24, v16, v17
    v_add_f32 v24, v24, v18
    v_add_f32 v24, v24, v19
    v_add_f32 v24, v24, v20
    v_add_f32 v24, v24, v21
    v_add_f32 v24, v24, v22
    v_add_f32 v24, v24, v23
    s_nop 1
    v_add_f32_dpp v24, v24, v24 quad_perm:[1,0,3,2] row_mask:0xf bank_mask:0xf
    s_nop 1
    v_add_f32_dpp v24, v24, v24 quad_perm:[2,3,0,1] row_mask:0xf bank_mask:0xf
    s_nop 1
    v_add_f32_dpp v24, v24, v24 row_half_mirror row_mask:0xf bank_mask:0xf
    s_nop 1
    v_add_f32_dpp v24, v24, v24 row_mirror row_mask:0xf bank_mask:0xf
    s_nop 1
    v_add_f32_dpp v24, v24, v24 row_bcast:15 row_mask:0xa bank_mask:0xf
    s_nop 1
    v_add_f32_dpp v24, v24, v24 row_bcast:31 row_mask:0xc bank_mask:0xf
    s_nop 1
    v_readlane_b32 s44, v24, 63
    s_nop 1
    v_mov_b32 v25, s44
    v_mul_f32 v25, 0x3b000000, v25
    v_sub_f32 v26, v16, v25
    v_mul_f32 v24, v26, v26
    v_sub_f32 v26, v17, v25
    v_fmac_f32 v24, v26, v26
    v_sub_f32 v26, v18, v25
    v_fmac_f32 v24, v26, v26
    v_sub_f32 v26, v19, v25
    v_fmac_f32 v24, v26, v26
    v_sub_f32 v26, v20, v25
    v_fmac_f32 v24, v26, v26
    v_sub_f32 v26, v21, v25
    v_fmac_f32 v24, v26, v26
    v_sub_f32 v26, v22, v25
    v_fmac_f32 v24, v26, v26
    v_sub_f32 v26, v23, v25
    v_fmac_f32 v24, v26, v26
    s_nop 1
    v_add_f32_dpp v24, v24, v24 quad_perm:[1,0,3,2] row_mask:0xf bank_mask:0xf
    s_nop 1
    v_add_f32_dpp v24, v24, v24 quad_perm:[2,3,0,1] row_mask:0xf bank_mask:0xf
    s_nop 1
    v_add_f32_dpp v24, v24, v24 row_half_mirror row_mask:0xf bank_mask:0xf
    s_nop 1
    v_add_f32_dpp v24, v24, v24 row_mirror row_mask:0xf bank_mask:0xf
    s_nop 1
    v_add_f32_dpp v24, v24, v24 row_bcast:15 row_mask:0xa bank_mask:0xf
    s_nop 1
    v_add_f32_dpp v24, v24, v24 row_bcast:31 row_mask:0xc bank_mask:0xf
    s_nop 1
    v_readlane_b32 s44, v24, 63
    v_cvt_pk_bf16_f32 v25, v25, v25
    v_and_b32 v25, s52, v25
    v_mov_b32 v24, s44
    v_mul_f32 v24, 0x3b000000, v24
    v_cvt_pk_bf16_f32 v24, v24, v24
    v_and_b32 v24, s52, v24
    v_add_f32 v24, 0x3727c5ac, v24
    v_cvt_pk_bf16_f32 v24, v24, v24
    v_and_b32 v24, s52, v24
    v_sqrt_f32 v24, v24
    s_nop 0
    v_cvt_pk_bf16_f32 v24, v24, v24
    v_and_b32 v24, s52, v24
    v_rcp_f32 v24, v24
    v_readfirstlane_b32 s40, v25
    v_readfirstlane_b32 s41, v24
    v_sub_f32 v16, v16, v25
    v_sub_f32 v17, v17, v25
    v_sub_f32 v18, v18, v25
    v_sub_f32 v19, v19, v25
    v_sub_f32 v20, v20, v25
    v_sub_f32 v21, v21, v25
    v_sub_f32 v22, v22, v25
    v_sub_f32 v23, v23, v25
    v_cvt_pk_bf16_f32 v4, v16, v17
    v_cvt_pk_bf16_f32 v5, v18, v19
    v_cvt_pk_bf16_f32 v6, v20, v21
    v_cvt_pk_bf16_f32 v7, v22, v23
    v_lshlrev_b32 v16, 16, v4
    v_and_b32 v17, s52, v4
    v_lshlrev_b32 v18, 16, v5
    v_and_b32 v19, s52, v5
    v_lshlrev_b32 v20, 16, v6
    v_and_b32 v21, s52, v6
    v_lshlrev_b32 v22, 16, v7
    v_and_b32 v23, s52, v7
    v_mul_f32 v16, v16, v24
    v_mul_f32 v17, v17, v24
    v_mul_f32 v18, v18, v24
    v_mul_f32 v19, v19, v24
    v_mul_f32 v20, v20, v24
    v_mul_f32 v21, v21, v24
    v_mul_f32 v22, v22, v24
    v_mul_f32 v23, v23, v24
    v_cvt_pk_bf16_f32 v4, v16, v17
    v_cvt_pk_bf16_f32 v5, v18, v19
    v_cvt_pk_bf16_f32 v6, v20, v21
    v_cvt_pk_bf16_f32 v7, v22, v23
    v_add_u32 v8, 151808, v8
    ds_write_b128 v8, v[4:7]
    s_mul_i32 s44, s32, 144
    s_add_u32 s44, s44, 151808
    v_lshl_add_u32 v8, v1, 2, s44
    ds_read_b32 v48, v8
    v_xor_b32 v10, 16, v8
    ds_read_b32 v49, v10
    v_xor_b32 v10, 32, v8
    ds_read_b32 v50, v10
    v_xor_b32 v10, 48, v8
    ds_read_b32 v51, v10
    v_xor_b32 v10, 64, v8
    ds_read_b32 v52, v10
    v_xor_b32 v10, 80, v8
    ds_read_b32 v53, v10
    v_xor_b32 v10, 96, v8
    ds_read_b32 v54, v10
    v_xor_b32 v10, 112, v8
    ds_read_b32 v55, v10
    v_mov_b32 v24, 0
    v_mov_b32 v25, 0
    v_mov_b32 v26, 0
    v_mov_b32 v27, 0
    v_mov_b32 v28, 0
    v_mov_b32 v29, 0
    v_mov_b32 v30, 0
    v_mov_b32 v31, 0
    s_xor_b32 s47, s46, 131072
    buffer_load_dwordx4 v[80:83], v9, s[36:39], s47 offen
    s_xor_b32 s47, s46, 139264
    buffer_load_dwordx4 v[84:87], v9, s[36:39], s47 offen
    s_xor_b32 s47, s46, 196608
    buffer_load_dwordx4 v[88:91], v9, s[36:39], s47 offen
    s_xor_b32 s47, s46, 204800
    buffer_load_dwordx4 v[92:95], v9, s[36:39], s47 offen
    v_xor_b32 v12, v1, v2
    v_lshlrev_b32 v12, 4, v12
    v_lshl_add_u32 v12, v2, 8, v12
    s_lshl_b32 s44, s32, 12
    v_add_u32 v12, s44, v12
    s_lshl_b32 s44, s32, 2
    v_add_u32 v13, s44, v3
    v_xor_b32 v20, 64, v12
    v_xor_b32 v21, 128, v12
    v_xor_b32 v22, 192, v12
    s_add_u32 s48, s32, 0
L_sp1:
    ds_read_b32 v14, v3 offset:0
    s_waitcnt lgkmcnt(0)
    v_readfirstlane_b32 s44, v14
    s_cmp_gt_i32 s44, s48
    s_cbranch_scc0 L_sp1
    ds_read_b128 v[32:35], v12
    ds_read_b128 v[36:39], v20
    ds_read_b128 v[40:43], v21
    ds_read_b128 v[44:47], v22
    v_mov_b32 v14, 1
    s_waitcnt lgkmcnt(0)
    ds_write_b32 v13, v14 offset:32
    v_and_b32 v10, 0xffff, v48
    v_lshlrev_b32 v11, 16, v48
    s_waitcnt vmcnt(7)
    v_dot2c_f32_bf16 v24, v10, v64
    v_dot2c_f32_bf16 v25, v11, v64
    v_dot2c_f32_bf16 v26, v10, v65
    v_dot2c_f32_bf16 v27, v11, v65
    v_dot2c_f32_bf16 v28, v10, v66
    v_dot2c_f32_bf16 v29, v11, v66
    v_dot2c_f32_bf16 v30, v10, v67
    v_dot2c_f32_bf16 v31, v11, v67
    v_lshrrev_b32 v10, 16, v48
    v_and_b32 v11, s52, v48
    s_waitcnt vmcnt(6)
    v_dot2c_f32_bf16 v24, v10, v68
    v_dot2c_f32_bf16 v25, v11, v68
    v_dot2c_f32_bf16 v26, v10, v69
    v_dot2c_f32_bf16 v27, v11, v69
    v_dot2c_f32_bf16 v28, v10, v70
    v_dot2c_f32_bf16 v29, v11, v70
    v_dot2c_f32_bf16 v30, v10, v71
    v_dot2c_f32_bf16 v31, v11, v71
    v_and_b32 v10, 0xffff, v49
    v_lshlrev_b32 v11, 16, v49
    s_waitcnt vmcnt(5)
    v_dot2c_f32_bf16 v24, v10, v72
    v_dot2c_f32_bf16 v25, v11, v72
    v_dot2c_f32_bf16 v26, v10, v73
    v_dot2c_f32_bf16 v27, v11, v73
    v_dot2c_f32_bf16 v28, v10, v74
    v_dot2c_f32_bf16 v29, v11, v74
    v_dot2c_f32_bf16 v30, v10, v75
    v_dot2c_f32_bf16 v31, v11, v75
    v_lshrrev_b32 v10, 16, v49
    v_and_b32 v11, s52, v49
    s_waitcnt vmcnt(4)
    v_dot2c_f32_bf16 v24, v10, v76
    v_dot2c_f32_bf16 v25, v11, v76
    v_dot2c_f32_bf16 v26, v10, v77
    v_dot2c_f32_bf16 v27, v11, v77
    v_dot2c_f32_bf16 v28, v10, v78
    v_dot2c_f32_bf16 v29, v11, v78
    v_dot2c_f32_bf16 v30, v10, v79
    v_dot2c_f32_bf16 v31, v11, v79
    v_and_b32 v10, 0xffff, v50
    v_lshlrev_b32 v11, 16, v50
    s_waitcnt vmcnt(3)
    s_xor_b32 s47, s46, 262144
    buffer_load_dwordx4 v[96:99], v9, s[36:39], s47 offen
    v_dot2c_f32_bf16 v24, v10, v80
    v_dot2c_f32_bf16 v25, v11, v80
    v_dot2c_f32_bf16 v26, v10, v81
    v_dot2c_f32_bf16 v27, v11, v81
    v_dot2c_f32_bf16 v28, v10, v82
    v_dot2c_f32_bf16 v29, v11, v82
    v_dot2c_f32_bf16 v30, v10, v83
    v_dot2c_f32_bf16 v31, v11, v83
    v_add_u32 v12, 0x8000, v12
    v_xor_b32 v20, 64, v12
    v_xor_b32 v21, 128, v12
    v_xor_b32 v22, 192, v12
    s_add_u32 s48, s32, 8
L_sp3:
    ds_read_b32 v14, v3 offset:0
    s_waitcnt lgkmcnt(0)
    v_readfirstlane_b32 s44, v14
    s_cmp_gt_i32 s44, s48
    s_cbranch_scc0 L_sp3
    ds_read_b128 v[128:131], v12
    ds_read_b128 v[132:135], v20
    ds_read_b128 v[136:139], v21
    ds_read_b128 v[140:143], v22
    v_mov_b32 v14, 2
    s_waitcnt lgkmcnt(0)
    ds_write_b32 v13, v14 offset:32
    v_lshrrev_b32 v10, 16, v50
    v_and_b32 v11, s52, v50
    s_waitcnt vmcnt(3)
    s_xor_b32 s47, s46, 270336
    buffer_load_dwordx4 v[100:103], v9, s[36:39], s47 offen
    v_dot2c_f32_bf16 v24, v10, v84
    v_dot2c_f32_bf16 v25, v11, v84
    v_dot2c_f32_bf16 v26, v10, v85
    v_dot2c_f32_bf16 v27, v11, v85
    v_dot2c_f32_bf16 v28, v10, v86
    v_dot2c_f32_bf16 v29, v11, v86
    v_dot2c_f32_bf16 v30, v10, v87
    v_dot2c_f32_bf16 v31, v11, v87
    v_and_b32 v10, 0xffff, v51
    v_lshlrev_b32 v11, 16, v51
    s_waitcnt vmcnt(3)
    s_xor_b32 s47, s46, 327680
    buffer_load_dwordx4 v[104:107], v9, s[36:39], s47 offen
    v_dot2c_f32_bf16 v24, v10, v88
    v_dot2c_f32_bf16 v25, v11, v88
    v_dot2c_f32_bf16 v26, v10, v89
    v_dot2c_f32_bf16 v27, v11, v89
    v_dot2c_f32_bf16 v28, v10, v90
    v_dot2c_f32_bf16 v29, v11, v90
    v_dot2c_f32_bf16 v30, v10, v91
    v_dot2c_f32_bf16 v31, v11, v91
    v_lshrrev_b32 v10, 16, v51
    v_and_b32 v11, s52, v51
    s_waitcnt vmcnt(3)
    s_xor_b32 s47, s46, 335872
    buffer_load_dwordx4 v[108:111], v9, s[36:39], s47 offen
    v_dot2c_f32_bf16 v24, v10, v92
    v_dot2c_f32_bf16 v25, v11, v92
    v_dot2c_f32_bf16 v26, v10, v93
    v_dot2c_f32_bf16 v27, v11, v93
    v_dot2c_f32_bf16 v28, v10, v94
    v_dot2c_f32_bf16 v29, v11, v94
    v_dot2c_f32_bf16 v30, v10, v95
    v_dot2c_f32_bf16 v31, v11, v95
    v_and_b32 v10, 0xffff, v52
    v_lshlrev_b32 v11, 16, v52
    s_waitcnt vmcnt(3)
    s_xor_b32 s47, s46, 393216
    buffer_load_dwordx4 v[112:115], v9, s[36:39], s47 offen
    v_dot2c_f32_bf16 v24, v10, v96
    v_dot2c_f32_bf16 v25, v11, v96
    v_dot2c_f32_bf16 v26, v10, v97
    v_dot2c_f32_bf16 v27, v11, v97
    v_dot2c_f32_bf16 v28, v10, v98
    v_dot2c_f32_bf16 v29, v11, v98
    v_dot2c_f32_bf16 v30, v10, v99
    v_dot2c_f32_bf16 v31, v11, v99
    v_add_u32 v12, 0x8000, v12
    v_xor_b32 v20, 64, v12
    v_xor_b32 v21, 128, v12
    v_xor_b32 v22, 192, v12
    s_add_u32 s48, s32, 16
L_sp5:
    ds_read_b32 v14, v3 offset:0
    s_waitcnt lgkmcnt(0)
    v_readfirstlane_b32 s44, v14
    s_cmp_gt_i32 s44, s48
    s_cbranch_scc0 L_sp5
    ds_read_b128 v[144:147], v12
    ds_read_b128 v[148:151], v20
    ds_read_b128 v[152:155], v21
    ds_read_b128 v[156:159], v22
    v_mov_b32 v14, 3
    s_waitcnt lgkmcnt(0)
    ds_write_b32 v13, v14 offset:32
    v_lshrrev_b32 v10, 16, v52
    v_and_b32 v11, s52, v52
    s_waitcnt vmcnt(3)
    s_xor_b32 s47, s46, 401408
    buffer_load_dwordx4 v[116:119], v9, s[36:39], s47 offen
    v_dot2c_f32_bf16 v24, v10, v100
    v_dot2c_f32_bf16 v25, v11, v100
    v_dot2c_f32_bf16 v26, v10, v101
    v_dot2c_f32_bf16 v27, v11, v101
    v_dot2c_f32_bf16 v28, v10, v102
    v_dot2c_f32_bf16 v29, v11, v102
    v_dot2c_f32_bf16 v30, v10, v103
    v_dot2c_f32_bf16 v31, v11, v103
    v_and_b32 v10, 0xffff, v53
    v_lshlrev_b32 v11, 16, v53
    s_waitcnt vmcnt(3)
    s_xor_b32 s47, s46, 458752
    buffer_load_dwordx4 v[120:123], v9, s[36:39], s47 offen
    v_dot2c_f32_bf16 v24, v10, v104
    v_dot2c_f32_bf16 v25, v11, v104
    v_dot2c_f32_bf16 v26, v10, v105
    v_dot2c_f32_bf16 v27, v11, v105
    v_dot2c_f32_bf16 v28, v10, v106
    v_dot2c_f32_bf16 v29, v11, v106
    v_dot2c_f32_bf16 v30, v10, v107
    v_dot2c_f32_bf16 v31, v11, v107
    v_lshrrev_b32 v10, 16, v53
    v_and_b32 v11, s52, v53
    s_waitcnt vmcnt(3)
    s_xor_b32 s47, s46, 466944
    buffer_load_dwordx4 v[124:127], v9, s[36:39], s47 offen
    v_dot2c_f32_bf16 v24, v10, v108
    v_dot2c_f32_bf16 v25, v11, v108
    v_dot2c_f32_bf16 v26, v10, v109
    v_dot2c_f32_bf16 v27, v11, v109
    v_dot2c_f32_bf16 v28, v10, v110
    v_dot2c_f32_bf16 v29, v11, v110
    v_dot2c_f32_bf16 v30, v10, v111
    v_dot2c_f32_bf16 v31, v11, v111
    v_and_b32 v10, 0xffff, v54
    v_lshlrev_b32 v11, 16, v54
    s_waitcnt vmcnt(3)
    v_dot2c_f32_bf16 v24, v10, v112
    v_dot2c_f32_bf16 v25, v11, v112
    v_dot2c_f32_bf16 v26, v10, v113
    v_dot2c_f32_bf16 v27, v11, v113
    v_dot2c_f32_bf16 v28, v10, v114
    v_dot2c_f32_bf16 v29, v11, v114
    v_dot2c_f32_bf16 v30, v10, v115
    v_dot2c_f32_bf16 v31, v11, v115
    v_lshrrev_b32 v10, 16, v54
    v_and_b32 v11, s52, v54
    s_waitcnt vmcnt(2)
    v_dot2c_f32_bf16 v24, v10, v116
    v_dot2c_f32_bf16 v25, v11, v116
    v_dot2c_f32_bf16 v26, v10, v117
    v_dot2c_f32_bf16 v27, v11, v117
    v_dot2c_f32_bf16 v28, v10, v118
    v_dot2c_f32_bf16 v29, v11, v118
    v_dot2c_f32_bf16 v30, v10, v119
    v_dot2c_f32_bf16 v31, v11, v119
    v_and_b32 v10, 0xffff, v55
    v_lshlrev_b32 v11, 16, v55
    s_waitcnt vmcnt(1)
    v_dot2c_f32_bf16 v24, v10, v120
    v_dot2c_f32_bf16 v25, v11, v120
    v_dot2c_f32_bf16 v26, v10, v121
    v_dot2c_f32_bf16 v27, v11, v121
    v_dot2c_f32_bf16 v28, v10, v122
    v_dot2c_f32_bf16 v29, v11, v122
    v_dot2c_f32_bf16 v30, v10, v123
    v_dot2c_f32_bf16 v31, v11, v123
    v_lshrrev_b32 v10, 16, v55
    v_and_b32 v11, s52, v55
    s_waitcnt vmcnt(0)
    v_dot2c_f32_bf16 v24, v10, v124
    v_dot2c_f32_bf16 v25, v11, v124
    v_dot2c_f32_bf16 v26, v10, v125
    v_dot2c_f32_bf16 v27, v11, v125
    v_dot2c_f32_bf16 v28, v10, v126
    v_dot2c_f32_bf16 v29, v11, v126
    v_dot2c_f32_bf16 v30, v10, v127
    v_dot2c_f32_bf16 v31, v11, v127
    s_mul_i32 s44, s32, 528
    s_add_u32 s44, s44, 147456
    v_lshl_add_u32 v15, v2, 5, s44
    v_lshl_add_u32 v15, v1, 3, v15
    v_permlane32_swap_b32 v24, v28
    v_permlane32_swap_b32 v25, v29
    v_permlane32_swap_b32 v26, v30
    v_permlane32_swap_b32 v27, v31
    v_pk_add_f32 v[24:25], v[24:25], v[28:29]
    v_pk_add_f32 v[26:27], v[26:27], v[30:31]
    s_nop 1
    v_permlane16_swap_b32 v24, v26
    v_permlane16_swap_b32 v25, v27
    v_pk_add_f32 v[24:25], v[24:25], v[26:27]
    ds_write_b64 v15, v[24:25]
    v_mov_b32 v10, 1
    s_waitcnt lgkmcnt(0)
    s_mov_b64 exec, 1
    ds_add_u32 v3, v10 offset:4
    s_mov_b64 exec, -1
    v_mov_b32 v160, v4
    v_mov_b32 v161, v5
    v_mov_b32 v162, v6
    v_mov_b32 v163, v7
    v_lshlrev_b32 v14, 3, v0
    v_add_u32 v14, 147456, v14
L_sp7:
    ds_read_b32 v10, v3 offset:4
    s_waitcnt lgkmcnt(0)
    v_readfirstlane_b32 s44, v10
    s_cmp_ge_u32 s44, 8
    s_cbranch_scc0 L_sp7
    ds_read_b64 v[112:113], v14 offset:0
    ds_read_b64 v[114:115], v14 offset:528
    ds_read_b64 v[116:117], v14 offset:1056
    ds_read_b64 v[118:119], v14 offset:1584
    ds_read_b64 v[120:121], v14 offset:2112
    ds_read_b64 v[122:123], v14 offset:2640
    ds_read_b64 v[124:125], v14 offset:3168
    ds_read_b64 v[126:127], v14 offset:3696
    s_waitcnt lgkmcnt(4)
    v_pk_add_f32 v[112:113], v[112:113], v[116:117]
    v_pk_add_f32 v[114:115], v[114:115], v[118:119]
    v_pk_add_f32 v[112:113], v[112:113], v[114:115]
    s_waitcnt lgkmcnt(0)
    v_pk_add_f32 v[120:121], v[120:121], v[124:125]
    v_pk_add_f32 v[122:123], v[122:123], v[126:127]
    v_pk_add_f32 v[120:121], v[120:121], v[122:123]
    v_pk_add_f32 v[112:113], v[112:113], v[120:121]
    v_cvt_pk_bf16_f32 v112, v112, v113
    v_lshlrev_b32 v10, 2, v0
    v_add_u32 v10, 151808, v10
    ds_write_b32 v10, v112
    v_lshlrev_b32 v10, 4, v1
    v_add_u32 v10, 151808, v10
    ds_read_b128 v[48:51], v10 offset:0
    ds_read_b128 v[52:55], v10 offset:64
    ds_read_b128 v[56:59], v10 offset:128
    ds_read_b128 v[60:63], v10 offset:192
    s_mov_b32 s14, 0x3fb8aa3b
    s_mov_b32 s55, 0x3db504f3
    v_and_b32 v4, 0x7fff, v12
    s_lshl_b32 s44, s32, 6
    s_add_u32 s44, s44, 131072
    v_lshl_add_u32 v5, v2, 2, s44
    v_mov_b32 v6, v13
    v_mov_b32 v7, 0xff7fffff
    v_mov_b32 v8, 0
    v_mov_b32 v9, 0
    s_mov_b32 s35, s32
    s_mov_b32 s34, 0
    s_lshl_b32 s44, s31, 17
    s_add_u32 s36, s12, s44
    s_addc_u32 s37, s13, 0
    s_mov_b32 s38, 131072
    s_lshl_b32 s44, s32, 7
    v_lshl_add_u32 v164, v2, 3, s44
    v_lshl_add_u32 v164, v1, 15, v164
    s_add_u32 s33, s32, 6
    s_mul_i32 s78, s78, 1664525
    s_add_u32 s78, s78, 1013904223
    s_waitcnt lgkmcnt(0)
    s_branch L_kmid
L_kst:
    v_mov_b32 v32, v128
    v_mov_b32 v33, v129
    v_mov_b32 v34, v130
    v_mov_b32 v35, v131
    v_mov_b32 v36, v132
    v_mov_b32 v37, v133
    v_mov_b32 v38, v134
    v_mov_b32 v39, v135
    v_mov_b32 v40, v136
    v_mov_b32 v41, v137
    v_mov_b32 v42, v138
    v_mov_b32 v43, v139
    v_mov_b32 v44, v140
    v_mov_b32 v45, v141
    v_mov_b32 v46, v142
    v_mov_b32 v47, v143
    v_mov_b32 v128, v144
    v_mov_b32 v129, v145
    v_mov_b32 v130, v146
    v_mov_b32 v131, v147
    v_mov_b32 v132, v148
    v_mov_b32 v133, v149
    v_mov_b32 v134, v150
    v_mov_b32 v135, v151
    v_mov_b32 v136, v152
    v_mov_b32 v137, v153
    v_mov_b32 v138, v154
    v_mov_b32 v139, v155
    v_mov_b32 v140, v156
    v_mov_b32 v141, v157
    v_mov_b32 v142, v158
    v_mov_b32 v143, v159
    s_branch L_kmid
L_k:
    s_cmp_lt_u32 s34, 3
    s_cbranch_scc1 L_kst
    v_xor_b32 v11, 64, v4
    v_xor_b32 v12, 128, v4
    v_xor_b32 v13, 192, v4
L_sp9:
    ds_read_b32 v10, v3 offset:0
    s_waitcnt lgkmcnt(0)
    v_readfirstlane_b32 s44, v10
    s_cmp_gt_i32 s44, s35
    s_cbranch_scc0 L_sp9
    ds_read_b128 v[32:35], v4
    ds_read_b128 v[36:39], v11
    ds_read_b128 v[40:43], v12
    ds_read_b128 v[44:47], v13
L_kmid:
    v_add_u32 v9, 1, v9
    v_add_u32 v4, 0x8000, v4
    v_and_b32 v4, 0x1ffff, v4
    s_waitcnt lgkmcnt(3)
    v_mfma_f32_16x16x32_bf16 v[16:19], v[48:51], v[32:35], 0
    s_waitcnt lgkmcnt(2)
    v_mfma_f32_16x16x32_bf16 v[16:19], v[52:55], v[36:39], v[16:19]
    s_waitcnt lgkmcnt(1)
    v_mfma_f32_16x16x32_bf16 v[16:19], v[56:59], v[40:43], v[16:19]
    s_waitcnt lgkmcnt(0)
    v_mfma_f32_16x16x32_bf16 v[16:19], v[60:63], v[44:47], v[16:19]
    v_max_u32 v10, 3, v9
    ds_write_b32 v6, v10 offset:32
    s_add_u32 s35, s35, 8
    s_nop 4
    v_cvt_pk_bf16_f32 v16, v16, v16
    v_and_b32 v16, s52, v16
    v_mul_f32 v16, s55, v16
    v_cvt_pk_bf16_f32 v16, v16, v16
    v_and_b32 v16, s52, v16
    ds_write_b32 v5, v16
    v_max_f32 v17, v7, v16
    v_sub_f32 v18, v7, v17
    v_sub_f32 v16, v16, v17
    v_mul_f32 v18, s14, v18
    v_mul_f32 v16, s14, v16
    v_exp_f32 v18, v18
    v_exp_f32 v16, v16
    v_mov_b32 v7, v17
    v_add_u32 v5, 512, v5
    v_fma_f32 v8, v8, v18, v16
    s_sub_u32 s45, s35, 220
    s_cmp_ge_u32 s45, 220
    s_cbranch_scc1 L_nck
    s_and_b32 s46, s45, 63
    s_lshr_b32 s45, s45, 6
    s_mul_i32 s47, s45, 34816
    s_add_u32 s47, s47, 0x200000
    s_cmp_ge_u32 s2, 8
    s_cbranch_scc1 L_csk
    s_add_u32 s48, s2, s45
    s_and_b32 s48, s48, 7
    s_mul_i32 s48, s48, 3
    s_cmp_eq_u32 s46, s48
    s_cbranch_scc0 L_csk
    v_mul_u32_u24 v10, 4352, v0
    s_lshl_b32 s48, s2, 2
    s_add_u32 s48, s48, s47
    v_add_u32 v10, s48, v10
    v_mov_b32 v11, s78
    s_mov_b64 exec, 0xff
    global_store_dword v10, v11, s[28:29] sc1
    s_mov_b64 exec, -1
L_csk:
    s_cmp_eq_u32 s46, 11
    s_cbranch_scc0 L_nck
    s_bfe_u32 s46, s2, 0x30003
    s_mul_i32 s46, s46, 4352
    s_add_u32 s47, s47, s46
    s_load_dwordx8 s[80:87], s[28:29], s47 glc
    s_mov_b32 s46, 4
    s_waitcnt lgkmcnt(0)
    s_cmp_eq_u32 s80, s78
    s_subb_u32 s46, s46, 0
    s_cmp_eq_u32 s81, s78
    s_subb_u32 s46, s46, 0
    s_cmp_eq_u32 s82, s78
    s_subb_u32 s46, s46, 0
    s_cmp_eq_u32 s83, s78
    s_subb_u32 s46, s46, 0
    s_cmp_eq_u32 s84, s78
    s_subb_u32 s46, s46, 0
    s_cmp_eq_u32 s85, s78
    s_subb_u32 s46, s46, 0
    s_cmp_eq_u32 s86, s78
    s_subb_u32 s46, s46, 0
    s_cmp_eq_u32 s87, s78
    s_subb_u32 s46, s46, 0
    s_mul_i32 s46, s46, 36
    s_add_u32 s46, s46, 165
    s_max_i32 s46, s46, 0
    s_min_i32 s46, s46, 255
    v_mov_b32 v11, s46
    ds_write_b32 v3, v11 offset:64
L_nck:
    s_cmp_lg_u32 s31, 0
    s_cbranch_scc1 L_npub
    s_sub_u32 s45, s35, 152
    s_cmp_ge_u32 s45, 32
    s_cbranch_scc1 L_nprobe
    s_lshl_b32 s45, s45, 8
    s_lshl_b32 s46, s30, 17
    s_add_u32 s46, s46, s45
    s_lshl_b32 s45, s45, 5
    s_and_b32 s45, s45, 0x2000
    s_add_u32 s46, s46, s45
    s_xor_b32 s47, s46, 0x2000
    s_load_dword s80, s[28:29], s46 glc
    s_load_dword s81, s[28:29], s47 glc
    s_waitcnt lgkmcnt(0)
    s_not_b32 s80, s80
    s_mov_b32 s82, s80
    s_movk_i32 s48, 2048
    s_load_dword s82, s[28:29], s46 glc
L_pw0:
    s_sub_u32 s48, s48, 1
    s_cbranch_scc1 L_pe0
    s_cmp_eq_u32 s82, s80
    s_cbranch_scc1 L_pw0
L_pe0:
    s_waitcnt lgkmcnt(0)
    s_not_b32 s81, s81
    s_mov_b32 s82, s81
    s_movk_i32 s49, 2048
    s_load_dword s82, s[28:29], s47 glc
L_pw1:
    s_sub_u32 s49, s49, 1
    s_cbranch_scc1 L_pe1
    s_cmp_eq_u32 s82, s81
    s_cbranch_scc1 L_pw1
L_pe1:
    s_waitcnt lgkmcnt(0)
    s_cmp_gt_i32 s49, s48
    s_cselect_b32 s46, s47, s46
    s_bitcmp1_b32 s46, 13
    s_cselect_b32 s48, 1, -1
    v_mov_b32 v11, s48
    s_mov_b64 exec, 1
    ds_add_u32 v3, v11 offset:16
    s_mov_b64 exec, -1
L_nprobe:
    s_cmp_lg_u32 s35, 200
    s_cbranch_scc1 L_npub
    ds_read_b32 v10, v3 offset:16
    s_lshl_b32 s45, s30, 11
    s_add_u32 s45, s45, 0x190000
    v_lshl_add_u32 v12, v0, 8, s45
    s_waitcnt lgkmcnt(0)
    v_readfirstlane_b32 s46, v10
    s_cmp_gt_i32 s46, 0
    s_cselect_b32 s46, 1, 0
    s_xor_b32 s46, s46, s3
    v_mov_b32 v11, s46
    s_mov_b64 exec, 0xff
    global_store_dword v12, v11, s[28:29] sc1
    s_mov_b64 exec, -1
L_npub:
    s_cmp_lg_u32 s35, 248
    s_cbranch_scc1 L_nget
    s_lshl_b32 s45, s2, 6
    s_and_b32 s45, s45, 0x3f00
    s_add_u32 s45, s45, 0x190000
    s_mov_b32 s47, 0x100000
L_pget:
    s_load_dword s46, s[28:29], s45 glc
    s_sub_u32 s47, s47, 1
    s_waitcnt lgkmcnt(0)
    s_cbranch_scc1 L_pgot
    s_xor_b32 s46, s46, s3
    s_cmp_gt_u32 s46, 1
    s_cbranch_scc1 L_pget
L_pgot:
    s_and_b32 s46, s46, 1
    s_lshl_b32 s46, s46, 13
    v_mov_b32 v11, s46
    ds_write_b32 v3, v11 offset:20
L_nget:
    s_cmp_lg_u32 s34, 6
    s_cbranch_scc1 L_wo0
    s_movk_i32 s45, 0
    buffer_load_dwordx2 v[64:65], v164, s[36:39], s45 offen nt
    buffer_load_dwordx2 v[66:67], v164, s[36:39], s45 offen offset:1024 nt
L_wo0:
    s_cmp_lg_u32 s34, 7
    s_cbranch_scc1 L_wo1
    s_movk_i32 s45, 2048
    buffer_load_dwordx2 v[68:69], v164, s[36:39], s45 offen nt
    buffer_load_dwordx2 v[70:71], v164, s[36:39], s45 offen offset:1024 nt
L_wo1:
    s_cmp_lg_u32 s34, 9
    s_cbranch_scc1 L_wo2
    s_movk_i32 s45, 4096
    buffer_load_dwordx2 v[72:73], v164, s[36:39], s45 offen nt
    buffer_load_dwordx2 v[74:75], v164, s[36:39], s45 offen offset:1024 nt
L_wo2:
    s_cmp_lg_u32 s34, 10
    s_cbranch_scc1 L_wo3
    s_movk_i32 s45, 6144
    buffer_load_dwordx2 v[76:77], v164, s[36:39], s45 offen nt
    buffer_load_dwordx2 v[78:79], v164, s[36:39], s45 offen offset:1024 nt
L_wo3:
    s_cmp_lg_u32 s34, 12
    s_cbranch_scc1 L_wo4
    s_movk_i32 s45, 8192
    buffer_load_dwordx2 v[80:81], v164, s[36:39], s45 offen nt
    buffer_load_dwordx2 v[82:83], v164, s[36:39], s45 offen offset:1024 nt
L_wo4:
    s_cmp_lg_u32 s34, 13
    s_cbranch_scc1 L_wo5
    s_movk_i32 s45, 10240
    buffer_load_dwordx2 v[84:85], v164, s[36:39], s45 offen nt
    buffer_load_dwordx2 v[86:87], v164, s[36:39], s45 offen offset:1024 nt
L_wo5:
    s_cmp_lg_u32 s34, 15
    s_cbranch_scc1 L_wo6
    s_movk_i32 s45, 12288
    buffer_load_dwordx2 v[88:89], v164, s[36:39], s45 offen nt
    buffer_load_dwordx2 v[90:91], v164, s[36:39], s45 offen offset:1024 nt
L_wo6:
    s_cmp_lg_u32 s34, 16
    s_cbranch_scc1 L_wo7
    s_movk_i32 s45, 14336
    buffer_load_dwordx2 v[92:93], v164, s[36:39], s45 offen nt
    buffer_load_dwordx2 v[94:95], v164, s[36:39], s45 offen offset:1024 nt
L_wo7:
    s_cmp_lg_u32 s34, 18
    s_cbranch_scc1 L_wo8
    s_movk_i32 s45, 16384
    buffer_load_dwordx2 v[96:97], v164, s[36:39], s45 offen nt
    buffer_load_dwordx2 v[98:99], v164, s[36:39], s45 offen offset:1024 nt
L_wo8:
    s_cmp_lg_u32 s34, 19
    s_cbranch_scc1 L_wo9
    s_movk_i32 s45, 18432
    buffer_load_dwordx2 v[100:101], v164, s[36:39], s45 offen nt
    buffer_load_dwordx2 v[102:103], v164, s[36:39], s45 offen offset:1024 nt
L_wo9:
    s_cmp_lg_u32 s34, 21
    s_cbranch_scc1 L_wo10
    s_movk_i32 s45, 20480
    buffer_load_dwordx2 v[104:105], v164, s[36:39], s45 offen nt
    buffer_load_dwordx2 v[106:107], v164, s[36:39], s45 offen offset:1024 nt
L_wo10:
    s_cmp_lg_u32 s34, 22
    s_cbranch_scc1 L_wo11
    s_movk_i32 s45, 22528
    buffer_load_dwordx2 v[108:109], v164, s[36:39], s45 offen nt
    buffer_load_dwordx2 v[110:111], v164, s[36:39], s45 offen offset:1024 nt
L_wo11:
    s_cmp_lg_u32 s34, 24
    s_cbranch_scc1 L_wo12
    s_movk_i32 s45, 24576
    buffer_load_dwordx2 v[112:113], v164, s[36:39], s45 offen nt
    buffer_load_dwordx2 v[114:115], v164, s[36:39], s45 offen offset:1024 nt
L_wo12:
    s_cmp_lg_u32 s34, 25
    s_cbranch_scc1 L_wo13
    s_movk_i32 s45, 26624
    buffer_load_dwordx2 v[116:117], v164, s[36:39], s45 offen nt
    buffer_load_dwordx2 v[118:119], v164, s[36:39], s45 offen offset:1024 nt
L_wo13:
    s_cmp_lg_u32 s34, 27
    s_cbranch_scc1 L_wo14
    s_movk_i32 s45, 28672
    buffer_load_dwordx2 v[120:121], v164, s[36:39], s45 offen nt
    buffer_load_dwordx2 v[122:123], v164, s[36:39], s45 offen offset:1024 nt
L_wo14:
    s_cmp_lg_u32 s34, 28
    s_cbranch_scc1 L_wo15
    s_movk_i32 s45, 30720
    buffer_load_dwordx2 v[124:125], v164, s[36:39], s45 offen nt
    buffer_load_dwordx2 v[126:127], v164, s[36:39], s45 offen offset:1024 nt
L_wo15:
    s_cmp_lg_u32 s34, s33
    s_cbranch_scc1 L_nomx
    s_lshl_b32 s44, s31, 5
    v_lshl_add_u32 v11, v2, 1, s44
    global_load_ushort v138, v11, s[4:5]
    s_mul_i32 s44, s32, 448
    v_mul_u32_u24 v11, 112, v1
    v_lshl_add_u32 v11, v2, 2, v11
    v_add_u32 v11, s44, v11
    v_cmp_lt_u32 vcc, 13, v2
    v_mov_b32 v12, 0x10000
    s_movk_i32 s58, 3584
    v_cndmask_b32 v11, v11, v12, vcc
    s_mov_b32 s56, s16
    s_mov_b32 s57, s17
    buffer_load_dword v129, v11, s[56:59], 0 offen offset:0
    buffer_load_dword v134, v11, s[56:59], 0 offen offset:56
    s_mov_b32 s56, s18
    s_mov_b32 s57, s19
    buffer_load_dword v131, v11, s[56:59], 0 offen offset:0
    buffer_load_dword v136, v11, s[56:59], 0 offen offset:56
    s_mov_b32 s56, s20
    s_mov_b32 s57, s21
    buffer_load_dword v132, v11, s[56:59], 0 offen offset:0
    buffer_load_dword v137, v11, s[56:59], 0 offen offset:56
    v_mov_b32 v12, 0
    global_load_ushort v146, v12, s[22:23]
    s_lshl_b32 s44, s30, 8
    s_add_u32 s44, s44, 0x180000
    s_load_dword s3, s[28:29], s44
L_nomx:
    s_cmp_lg_u32 s34, 15
    s_cbranch_scc1 L_noms
    v_lshlrev_b32 v16, 16, v160
    v_and_b32 v17, s52, v160
    v_lshlrev_b32 v18, 16, v161
    v_and_b32 v19, s52, v161
    v_lshlrev_b32 v20, 16, v162
    v_and_b32 v21, s52, v162
    v_lshlrev_b32 v22, 16, v163
    v_and_b32 v23, s52, v163
    v_add_f32 v24, v16, v17
    v_add_f32 v24, v24, v18
    v_add_f32 v24, v24, v19
    v_add_f32 v24, v24, v20
    v_add_f32 v24, v24, v21
    v_add_f32 v24, v24, v22
    v_add_f32 v24, v24, v23
    s_nop 1
    v_add_f32_dpp v24, v24, v24 quad_perm:[1,0,3,2] row_mask:0xf bank_mask:0xf
    s_nop 1
    v_add_f32_dpp v24, v24, v24 quad_perm:[2,3,0,1] row_mask:0xf bank_mask:0xf
    s_nop 1
    v_add_f32_dpp v24, v24, v24 row_half_mirror row_mask:0xf bank_mask:0xf
    s_nop 1
    v_add_f32_dpp v24, v24, v24 row_mirror row_mask:0xf bank_mask:0xf
    s_nop 1
    v_add_f32_dpp v24, v24, v24 row_bcast:15 row_mask:0xa bank_mask:0xf
    s_nop 1
    v_add_f32_dpp v24, v24, v24 row_bcast:31 row_mask:0xc bank_mask:0xf
    s_nop 1
    v_readlane_b32 s44, v24, 63
    s_nop 1
    v_mov_b32 v25, s44
    v_mul_f32 v25, 0x3b000000, v25
    v_sub_f32 v26, v16, v25
    v_mul_f32 v24, v26, v26
    v_sub_f32 v26, v17, v25
    v_fmac_f32 v24, v26, v26
    v_sub_f32 v26, v18, v25
    v_fmac_f32 v24, v26, v26
    v_sub_f32 v26, v19, v25
    v_fmac_f32 v24, v26, v26
    v_sub_f32 v26, v20, v25
    v_fmac_f32 v24, v26, v26
    v_sub_f32 v26, v21, v25
    v_fmac_f32 v24, v26, v26
    v_sub_f32 v26, v22, v25
    v_fmac_f32 v24, v26, v26
    v_sub_f32 v26, v23, v25
    v_fmac_f32 v24, v26, v26
    s_nop 1
    v_add_f32_dpp v24, v24, v24 quad_perm:[1,0,3,2] row_mask:0xf bank_mask:0xf
    s_nop 1
    v_add_f32_dpp v24, v24, v24 quad_perm:[2,3,0,1] row_mask:0xf bank_mask:0xf
    s_nop 1
    v_add_f32_dpp v24, v24, v24 row_half_mirror row_mask:0xf bank_mask:0xf
    s_nop 1
    v_add_f32_dpp v24, v24, v24 row_mirror row_mask:0xf bank_mask:0xf
    s_nop 1
    v_add_f32_dpp v24, v24, v24 row_bcast:15 row_mask:0xa bank_mask:0xf
    s_nop 1
    v_add_f32_dpp v24, v24, v24 row_bcast:31 row_mask:0xc bank_mask:0xf
    s_nop 1
    v_readlane_b32 s44, v24, 63
    v_cvt_pk_bf16_f32 v25, v25, v25
    v_and_b32 v25, s52, v25
    v_mov_b32 v24, s44
    v_mul_f32 v24, 0x3b000000, v24
    v_cvt_pk_bf16_f32 v24, v24, v24
    v_and_b32 v24, s52, v24
    v_add_f32 v24, 0x3727c5ac, v24
    v_cvt_pk_bf16_f32 v24, v24, v24
    v_and_b32 v24, s52, v24
    v_sqrt_f32 v24, v24
    s_nop 0
    v_cvt_pk_bf16_f32 v24, v24, v24
    v_and_b32 v24, s52, v24
    v_rcp_f32 v24, v24
    v_readfirstlane_b32 s42, v25
    v_readfirstlane_b32 s43, v24
    s_waitcnt vmcnt(0)
    v_lshlrev_b32 v138, 16, v138
    v_mov_b32 v145, v138
    v_subrev_f32 v138, s40, v138
    v_cvt_pk_bf16_f32 v138, v138, v138
    v_and_b32 v138, s52, v138
    v_mul_f32 v138, s41, v138
    v_cvt_pk_bf16_f32 v138, v138, v138
    v_and_b32 v138, s52, v138
    v_subrev_f32 v138, s42, v138
    v_cvt_pk_bf16_f32 v138, v138, v138
    v_and_b32 v138, s52, v138
    v_mul_f32 v138, s43, v138
    v_cvt_pk_bf16_f32 v138, v138, v138
    v_and_b32 v138, s52, v138
    v_lshlrev_b32 v128, 16, v129
    v_and_b32 v129, s52, v129
    v_lshlrev_b32 v130, 16, v131
    v_and_b32 v131, s52, v131
    v_lshlrev_b32 v133, 16, v134
    v_and_b32 v134, s52, v134
    v_lshlrev_b32 v135, 16, v136
    v_and_b32 v136, s52, v136
    v_mov_b32 v140, 0xc0135761
    s_mov_b32 s15, 0xbdd2d3e8
    v_mov_b32 v139, 0
    s_mul_i32 s3, s3, 1664525
    s_add_u32 s3, s3, 1013904223
L_noms:
    s_cmp_lt_u32 s34, 16
    s_cbranch_scc1 L_nomix
    v_mul_f32_dpp v16, v128, v138 row_newbcast:0 row_mask:0xf bank_mask:0xf
    v_mul_f32_dpp v17, v129, v138 row_newbcast:0 row_mask:0xf bank_mask:0xf
    v_cvt_pk_bf16_f32 v17, v16, v17
    v_lshlrev_b32 v16, 16, v17
    v_and_b32 v17, s52, v17
    v_add_f32_dpp v16, v130, v16 row_newbcast:0 row_mask:0xf bank_mask:0xf
    v_add_f32_dpp v17, v131, v17 row_newbcast:0 row_mask:0xf bank_mask:0xf
    v_cvt_pk_bf16_f32 v17, v16, v17
    v_lshlrev_b32 v16, 16, v17
    v_and_b32 v17, s52, v17
    v_mul_f32 v18, v16, v16
    v_mul_f32 v19, v17, v17
    v_fma_f32 v18, v18, s15, v140
    v_fma_f32 v19, v19, s15, v140
    v_mul_f32 v18, v18, v16
    v_mul_f32 v19, v19, v17
    v_exp_f32 v18, v18
    v_exp_f32 v19, v19
    v_mov_b32_dpp v128, v128 row_ror:15 row_mask:0xf bank_mask:0xf
    v_add_f32 v18, 1.0, v18
    v_add_f32 v19, 1.0, v19
    v_rcp_f32 v18, v18
    v_rcp_f32 v19, v19
    v_mov_b32_dpp v129, v129 row_ror:15 row_mask:0xf bank_mask:0xf
    v_mul_f32 v18, v18, v16
    v_mul_f32 v19, v19, v17
    v_cvt_pk_bf16_f32 v18, v18, v19
    v_mov_b32_dpp v130, v130 row_ror:15 row_mask:0xf bank_mask:0xf
    v_mov_b32_dpp v131, v131 row_ror:15 row_mask:0xf bank_mask:0xf
    v_dot2c_f32_bf16_dpp v139, v132, v18 row_newbcast:0 row_mask:0xf bank_mask:0xf
    v_mov_b32_dpp v132, v132 row_ror:15 row_mask:0xf bank_mask:0xf
    v_mul_f32_dpp v16, v133, v138 row_newbcast:0 row_mask:0xf bank_mask:0xf
    v_mul_f32_dpp v17, v134, v138 row_newbcast:0 row_mask:0xf bank_mask:0xf
    v_cvt_pk_bf16_f32 v17, v16, v17
    v_lshlrev_b32 v16, 16, v17
    v_and_b32 v17, s52, v17
    v_add_f32_dpp v16, v135, v16 row_newbcast:0 row_mask:0xf bank_mask:0xf
    v_add_f32_dpp v17, v136, v17 row_newbcast:0 row_mask:0xf bank_mask:0xf
    v_cvt_pk_bf16_f32 v17, v16, v17
    v_lshlrev_b32 v16, 16, v17
    v_and_b32 v17, s52, v17
    v_mul_f32 v18, v16, v16
    v_mul_f32 v19, v17, v17
    v_fma_f32 v18, v18, s15, v140
    v_fma_f32 v19, v19, s15, v140
    v_mul_f32 v18, v18, v16
    v_mul_f32 v19, v19, v17
    v_exp_f32 v18, v18
    v_exp_f32 v19, v19
    v_mov_b32_dpp v133, v133 row_ror:15 row_mask:0xf bank_mask:0xf
    v_add_f32 v18, 1.0, v18
    v_add_f32 v19, 1.0, v19
    v_rcp_f32 v18, v18
    v_rcp_f32 v19, v19
    v_mov_b32_dpp v134, v134 row_ror:15 row_mask:0xf bank_mask:0xf
    v_mul_f32 v18, v18, v16
    v_mul_f32 v19, v19, v17
    v_cvt_pk_bf16_f32 v18, v18, v19
    v_mov_b32_dpp v135, v135 row_ror:15 row_mask:0xf bank_mask:0xf
    v_mov_b32_dpp v136, v136 row_ror:15 row_mask:0xf bank_mask:0xf
    v_dot2c_f32_bf16_dpp v139, v137, v18 row_newbcast:0 row_mask:0xf bank_mask:0xf
    v_mov_b32_dpp v137, v137 row_ror:15 row_mask:0xf bank_mask:0xf
L_nomix:
    s_add_u32 s34, s34, 1
    s_cmp_lt_u32 s34, 32
    s_cbranch_scc1 L_k
    v_mov_b32 v16, v7
    s_nop 1
    v_max_f32_dpp v16, v16, v16 quad_perm:[1,0,3,2] row_mask:0xf bank_mask:0xf
    s_nop 1
    v_max_f32_dpp v16, v16, v16 quad_perm:[2,3,0,1] row_mask:0xf bank_mask:0xf
    s_nop 1
    v_max_f32_dpp v16, v16, v16 row_half_mirror row_mask:0xf bank_mask:0xf
    s_nop 1
    v_max_f32_dpp v16, v16, v16 row_mirror row_mask:0xf bank_mask:0xf
    v_sub_f32 v17, v7, v16
    v_mul_f32 v17, s14, v17
    v_exp_f32 v17, v17
    s_lshl_b32 s44, s32, 3
    v_add_u32 v18, s44, v3
    v_mul_f32 v17, v17, v8
    s_nop 1
    v_add_f32_dpp v17, v17, v17 quad_perm:[1,0,3,2] row_mask:0xf bank_mask:0xf
    s_nop 1
    v_add_f32_dpp v17, v17, v17 quad_perm:[2,3,0,1] row_mask:0xf bank_mask:0xf
    s_nop 1
    v_add_f32_dpp v17, v17, v17 row_half_mirror row_mask:0xf bank_mask:0xf
    s_nop 1
    v_add_f32_dpp v17, v17, v17 row_mirror row_mask:0xf bank_mask:0xf
    ds_write_b64 v18, v[16:17] offset:192
    v_mov_b32 v19, v139
    s_nop 1
    v_permlane32_swap_b32 v139, v19
    v_add_f32 v139, v139, v19
    v_mov_b32 v19, v139
    s_nop 1
    v_permlane16_swap_b32 v139, v19
    v_add_f32 v139, v139, v19
    s_lshl_b32 s44, s32, 6
    s_add_u32 s44, s44, 152832
    v_lshl_add_u32 v19, v2, 2, s44
    ds_write_b32 v19, v139
    v_mov_b32 v10, 1
    s_waitcnt lgkmcnt(0)
    s_mov_b64 exec, 1
    ds_add_u32 v3, v10 offset:8
    s_mov_b64 exec, -1
    s_mov_b32 s44, 0x05040100
    s_mov_b32 s45, 0x07060302
    s_waitcnt vmcnt(0)
    v_perm_b32 v16, v66, v64, s44
    v_perm_b32 v66, v66, v64, s45
    v_mov_b32 v64, v16
    v_perm_b32 v16, v67, v65, s44
    v_perm_b32 v67, v67, v65, s45
    v_mov_b32 v65, v16
    v_perm_b32 v16, v70, v68, s44
    v_perm_b32 v70, v70, v68, s45
    v_mov_b32 v68, v16
    v_perm_b32 v16, v71, v69, s44
    v_perm_b32 v71, v71, v69, s45
    v_mov_b32 v69, v16
    v_perm_b32 v16, v74, v72, s44
    v_perm_b32 v74, v74, v72, s45
    v_mov_b32 v72, v16
    v_perm_b32 v16, v75, v73, s44
    v_perm_b32 v75, v75, v73, s45
    v_mov_b32 v73, v16
    v_perm_b32 v16, v78, v76, s44
    v_perm_b32 v78, v78, v76, s45
    v_mov_b32 v76, v16
    v_perm_b32 v16, v79, v77, s44
    v_perm_b32 v79, v79, v77, s45
    v_mov_b32 v77, v16
    v_perm_b32 v16, v82, v80, s44
    v_perm_b32 v82, v82, v80, s45
    v_mov_b32 v80, v16
    v_perm_b32 v16, v83, v81, s44
    v_perm_b32 v83, v83, v81, s45
    v_mov_b32 v81, v16
    v_perm_b32 v16, v86, v84, s44
    v_perm_b32 v86, v86, v84, s45
    v_mov_b32 v84, v16
    v_perm_b32 v16, v87, v85, s44
    v_perm_b32 v87, v87, v85, s45
    v_mov_b32 v85, v16
    v_perm_b32 v16, v90, v88, s44
    v_perm_b32 v90, v90, v88, s45
    v_mov_b32 v88, v16
    v_perm_b32 v16, v91, v89, s44
    v_perm_b32 v91, v91, v89, s45
    v_mov_b32 v89, v16
    v_perm_b32 v16, v94, v92, s44
    v_perm_b32 v94, v94, v92, s45
    v_mov_b32 v92, v16
    v_perm_b32 v16, v95, v93, s44
    v_perm_b32 v95, v95, v93, s45
    v_mov_b32 v93, v16
    v_perm_b32 v16, v98, v96, s44
    v_perm_b32 v98, v98, v96, s45
    v_mov_b32 v96, v16
    v_perm_b32 v16, v99, v97, s44
    v_perm_b32 v99, v99, v97, s45
    v_mov_b32 v97, v16
    v_perm_b32 v16, v102, v100, s44
    v_perm_b32 v102, v102, v100, s45
    v_mov_b32 v100, v16
    v_perm_b32 v16, v103, v101, s44
    v_perm_b32 v103, v103, v101, s45
    v_mov_b32 v101, v16
    v_perm_b32 v16, v106, v104, s44
    v_perm_b32 v106, v106, v104, s45
    v_mov_b32 v104, v16
    v_perm_b32 v16, v107, v105, s44
    v_perm_b32 v107, v107, v105, s45
    v_mov_b32 v105, v16
    v_perm_b32 v16, v110, v108, s44
    v_perm_b32 v110, v110, v108, s45
    v_mov_b32 v108, v16
    v_perm_b32 v16, v111, v109, s44
    v_perm_b32 v111, v111, v109, s45
    v_mov_b32 v109, v16
    v_perm_b32 v16, v114, v112, s44
    v_perm_b32 v114, v114, v112, s45
    v_mov_b32 v112, v16
    v_perm_b32 v16, v115, v113, s44
    v_perm_b32 v115, v115, v113, s45
    v_mov_b32 v113, v16
    v_perm_b32 v16, v118, v116, s44
    v_perm_b32 v118, v118, v116, s45
    v_mov_b32 v116, v16
    v_perm_b32 v16, v119, v117, s44
    v_perm_b32 v119, v119, v117, s45
    v_mov_b32 v117, v16
    v_perm_b32 v16, v122, v120, s44
    v_perm_b32 v122, v122, v120, s45
    v_mov_b32 v120, v16
    v_perm_b32 v16, v123, v121, s44
    v_perm_b32 v123, v123, v121, s45
    v_mov_b32 v121, v16
    v_perm_b32 v16, v126, v124, s44
    v_perm_b32 v126, v126, v124, s45
    v_mov_b32 v124, v16
    v_perm_b32 v16, v127, v125, s44
    v_perm_b32 v127, v127, v125, s45
    v_mov_b32 v125, v16
    s_mov_b64 exec, 0
    s_branch L_tailb
L_dryret:
    s_mov_b64 exec, -1
    s_lshl_b32 s44, s30, 17
    s_add_u32 s56, s28, s44
    s_addc_u32 s57, s29, 0
    s_mov_b32 s58, 0x20000
    s_lshl_b32 s44, s32, 14
    s_lshl_b32 s45, s31, 7
    s_add_u32 s44, s44, s45
    v_lshrrev_b32 v12, 2, v2
    v_lshl_add_u32 v13, v12, 12, s44
    v_and_b32 v12, 3, v2
    v_lshl_add_u32 v13, v12, 5, v13
    v_lshl_add_u32 v13, v1, 3, v13
    v_lshrrev_b32 v12, 1, v13
    v_xor_b32 v12, v12, v13
    v_and_b32 v12, 0x2000, v12
    v_mul_u32_u24 v12, 3, v12
    v_xor_b32 v13, v12, v13
L_sp11:
    ds_read_b32 v10, v3 offset:8
    s_waitcnt lgkmcnt(0)
    v_readfirstlane_b32 s44, v10
    s_cmp_ge_u32 s44, 8
    s_cbranch_scc0 L_sp11
    v_and_b32 v18, 7, v0
    v_lshl_add_u32 v18, v18, 3, v3
    ds_read_b64 v[16:17], v18 offset:192
    v_lshlrev_b32 v19, 2, v0
    v_add_u32 v18, 152832, v19
    ds_read_b32 v20, v18
    ds_read_b32 v21, v18 offset:256
    ds_read_b32 v12, v3 offset:20
    s_waitcnt lgkmcnt(0)
    v_xor_b32 v13, v12, v13
    v_mov_b32 v7, v16
    s_nop 1
    v_max_f32_dpp v7, v7, v7 quad_perm:[1,0,3,2] row_mask:0xf bank_mask:0xf
    s_nop 1
    v_max_f32_dpp v7, v7, v7 quad_perm:[2,3,0,1] row_mask:0xf bank_mask:0xf
    s_nop 1
    v_max_f32_dpp v7, v7, v7 row_half_mirror row_mask:0xf bank_mask:0xf
    v_sub_f32 v16, v16, v7
    v_mul_f32 v16, s14, v16
    v_exp_f32 v16, v16
    v_add_f32 v20, v20, v21
    v_mul_f32 v8, v16, v17
    s_nop 1
    v_add_f32_dpp v8, v8, v8 quad_perm:[1,0,3,2] row_mask:0xf bank_mask:0xf
    s_nop 1
    v_add_f32_dpp v8, v8, v8 quad_perm:[2,3,0,1] row_mask:0xf bank_mask:0xf
    s_nop 1
    v_add_f32_dpp v8, v8, v8 row_half_mirror row_mask:0xf bank_mask:0xf
    v_rcp_f32 v8, v8
    v_mov_b32 v21, v20
    s_nop 1
    v_permlane32_swap_b32 v20, v21
    v_add_f32 v20, v20, v21
    v_mov_b32 v21, v20
    s_nop 1
    v_permlane16_swap_b32 v20, v21
    v_add_f32 v20, v20, v21
    v_cvt_pk_bf16_f32 v20, v20, v20
    v_and_b32 v20, s52, v20
    v_lshlrev_b32 v146, 16, v146
    v_add_f32 v20, v146, v20
    v_cvt_pk_bf16_f32 v20, v20, v20
    v_and_b32 v20, s52, v20
    v_lshl_add_u32 v18, v2, 2, v3
    v_mov_b32 v19, s3
    ds_write_b32 v18, v145 offset:256
    ds_write_b32 v18, v20 offset:320
    ds_write_b32 v3, v19 offset:12
    s_lshl_b32 s44, s32, 12
    v_lshl_add_u32 v4, v0, 4, s44
    v_and_b32 v5, 3, v0
    v_lshl_add_u32 v5, v5, 2, v1
    s_lshl_b32 s44, s32, 6
    s_add_u32 s44, s44, 131072
    v_lshl_add_u32 v5, v5, 2, s44
    v_mov_b32 v24, 0
    v_mov_b32 v25, 0
    v_mov_b32 v26, 0
    v_mov_b32 v27, 0
    v_mov_b32 v28, 0
    v_mov_b32 v29, 0
    v_mov_b32 v30, 0
    v_mov_b32 v31, 0
    v_mov_b32 v48, 0
    v_mov_b32 v50, 0
    v_mov_b32 v51, 0
    v_mov_b32 v52, 0
    v_mov_b32 v49, s3
    s_branch L_v
L_vc:
    s_sub_u32 s45, s35, 220
    s_cmp_ge_u32 s45, 220
    s_cbranch_scc1 L_ncv
    s_and_b32 s46, s45, 63
    s_lshr_b32 s45, s45, 6
    s_mul_i32 s47, s45, 34816
    s_add_u32 s47, s47, 0x200000
    s_cmp_ge_u32 s2, 8
    s_cbranch_scc1 L_csv
    s_add_u32 s48, s2, s45
    s_and_b32 s48, s48, 7
    s_mul_i32 s48, s48, 3
    s_cmp_eq_u32 s46, s48
    s_cbranch_scc0 L_csv
    v_mul_u32_u24 v10, 4352, v0
    s_lshl_b32 s48, s2, 2
    s_add_u32 s48, s48, s47
    v_add_u32 v10, s48, v10
    v_mov_b32 v11, s78
    s_mov_b64 exec, 0xff
    global_store_dword v10, v11, s[28:29] sc1
    s_mov_b64 exec, -1
L_csv:
    s_cmp_eq_u32 s46, 11
    s_cbranch_scc0 L_ncv
    s_bfe_u32 s46, s2, 0x30003
    s_mul_i32 s46, s46, 4352
    s_add_u32 s47, s47, s46
    s_load_dwordx8 s[80:87], s[28:29], s47 glc
    s_mov_b32 s46, 4
    s_waitcnt lgkmcnt(0)
    s_cmp_eq_u32 s80, s78
    s_subb_u32 s46, s46, 0
    s_cmp_eq_u32 s81, s78
    s_subb_u32 s46, s46, 0
    s_cmp_eq_u32 s82, s78
    s_subb_u32 s46, s46, 0
    s_cmp_eq_u32 s83, s78
    s_subb_u32 s46, s46, 0
    s_cmp_eq_u32 s84, s78
    s_subb_u32 s46, s46, 0
    s_cmp_eq_u32 s85, s78
    s_subb_u32 s46, s46, 0
    s_cmp_eq_u32 s86, s78
    s_subb_u32 s46, s46, 0
    s_cmp_eq_u32 s87, s78
    s_subb_u32 s46, s46, 0
    s_mul_i32 s46, s46, 36
    s_add_u32 s46, s46, 165
    s_max_i32 s46, s46, 0
    s_min_i32 s46, s46, 255
    v_mov_b32 v11, s46
    ds_write_b32 v3, v11 offset:64
L_ncv:
    s_sub_u32 s45, s35, 448
    s_cmp_ge_u32 s45, 42
    s_cbranch_scc1 L_ncw
    s_and_b32 s46, s45, 31
    s_lshr_b32 s45, s45, 5
    s_mul_i32 s47, s45, 34816
    s_add_u32 s47, s47, 0x300000
    s_cmp_ge_u32 s2, 8
    s_cbranch_scc1 L_csw
    s_add_u32 s48, s2, s45
    s_and_b32 s48, s48, 7
    s_mul_i32 s48, s48, 2
    s_cmp_eq_u32 s46, s48
    s_cbranch_scc0 L_csw
    v_mul_u32_u24 v10, 4352, v0
    s_lshl_b32 s48, s2, 2
    s_add_u32 s48, s48, s47
    v_add_u32 v10, s48, v10
    v_mov_b32 v11, s78
    s_mov_b64 exec, 0xff
    global_store_dword v10, v11, s[28:29] sc1
    s_mov_b64 exec, -1
L_csw:
    s_cmp_eq_u32 s46, 8
    s_cbranch_scc0 L_ncw
    s_bfe_u32 s46, s2, 0x30003
    s_mul_i32 s46, s46, 4352
    s_add_u32 s47, s47, s46
    s_load_dwordx8 s[80:87], s[28:29], s47 glc
    s_mov_b32 s46, 4
    s_waitcnt lgkmcnt(0)
    s_cmp_eq_u32 s80, s78
    s_subb_u32 s46, s46, 0
    s_cmp_eq_u32 s81, s78
    s_subb_u32 s46, s46, 0
    s_cmp_eq_u32 s82, s78
    s_subb_u32 s46, s46, 0
    s_cmp_eq_u32 s83, s78
    s_subb_u32 s46, s46, 0
    s_cmp_eq_u32 s84, s78
    s_subb_u32 s46, s46, 0
    s_cmp_eq_u32 s85, s78
    s_subb_u32 s46, s46, 0
    s_cmp_eq_u32 s86, s78
    s_subb_u32 s46, s46, 0
    s_cmp_eq_u32 s87, s78
    s_subb_u32 s46, s46, 0
    s_mul_i32 s46, s46, 60
    s_add_u32 s46, s46, 165
    s_max_i32 s46, s46, 0
    s_min_i32 s46, s46, 255
    v_mov_b32 v11, s46
    ds_write_b32 v3, v11 offset:64
L_ncw:
L_v:
    ds_read_b32 v16, v5
    v_add_u32 v5, 512, v5
    v_add_u32 v9, 1, v9
    s_waitcnt lgkmcnt(0)
    v_sub_f32 v16, v16, v7
    v_mul_f32 v16, s14, v16
    v_exp_f32 v16, v16
    s_nop 0
    v_mul_f32 v16, v16, v8
    v_cvt_pk_bf16_f32 v16, v16, v16
    v_lshrrev_b32 v17, 16, v16
    v_and_b32 v16, s52, v16
L_sp13:
    ds_read_b32 v10, v3 offset:0
    s_waitcnt lgkmcnt(0)
    v_readfirstlane_b32 s44, v10
    s_cmp_gt_i32 s44, s35
    s_cbranch_scc0 L_sp13
    ds_read_b128 v[32:35], v4 offset:0
    ds_read_b128 v[36:39], v4 offset:1024
    ds_read_b128 v[40:43], v4 offset:2048
    ds_read_b128 v[44:47], v4 offset:3072
    v_add_u32 v4, 0x8000, v4
    v_and_b32 v4, 0x1ffff, v4
    s_add_u32 s35, s35, 8
    s_cmpk_lt_u32 s35, 512
    s_waitcnt lgkmcnt(3)
    v_dot2c_f32_bf16_dpp v24, v17, v32 quad_perm:[0,0,0,0] row_mask:0xf bank_mask:0xf
    v_dot2c_f32_bf16_dpp v25, v16, v32 quad_perm:[0,0,0,0] row_mask:0xf bank_mask:0xf
    v_dot2c_f32_bf16_dpp v26, v17, v33 quad_perm:[0,0,0,0] row_mask:0xf bank_mask:0xf
    v_dot2c_f32_bf16_dpp v27, v16, v33 quad_perm:[0,0,0,0] row_mask:0xf bank_mask:0xf
    v_dot2c_f32_bf16_dpp v28, v17, v34 quad_perm:[0,0,0,0] row_mask:0xf bank_mask:0xf
    v_dot2c_f32_bf16_dpp v29, v16, v34 quad_perm:[0,0,0,0] row_mask:0xf bank_mask:0xf
    v_dot2c_f32_bf16_dpp v30, v17, v35 quad_perm:[0,0,0,0] row_mask:0xf bank_mask:0xf
    v_dot2c_f32_bf16_dpp v31, v16, v35 quad_perm:[0,0,0,0] row_mask:0xf bank_mask:0xf
    s_waitcnt lgkmcnt(2)
    v_dot2c_f32_bf16_dpp v24, v17, v36 quad_perm:[1,1,1,1] row_mask:0xf bank_mask:0xf
    v_dot2c_f32_bf16_dpp v25, v16, v36 quad_perm:[1,1,1,1] row_mask:0xf bank_mask:0xf
    v_dot2c_f32_bf16_dpp v26, v17, v37 quad_perm:[1,1,1,1] row_mask:0xf bank_mask:0xf
    v_dot2c_f32_bf16_dpp v27, v16, v37 quad_perm:[1,1,1,1] row_mask:0xf bank_mask:0xf
    v_dot2c_f32_bf16_dpp v28, v17, v38 quad_perm:[1,1,1,1] row_mask:0xf bank_mask:0xf
    v_dot2c_f32_bf16_dpp v29, v16, v38 quad_perm:[1,1,1,1] row_mask:0xf bank_mask:0xf
    v_dot2c_f32_bf16_dpp v30, v17, v39 quad_perm:[1,1,1,1] row_mask:0xf bank_mask:0xf
    v_dot2c_f32_bf16_dpp v31, v16, v39 quad_perm:[1,1,1,1] row_mask:0xf bank_mask:0xf
    s_waitcnt lgkmcnt(1)
    v_dot2c_f32_bf16_dpp v24, v17, v40 quad_perm:[2,2,2,2] row_mask:0xf bank_mask:0xf
    v_dot2c_f32_bf16_dpp v25, v16, v40 quad_perm:[2,2,2,2] row_mask:0xf bank_mask:0xf
    v_dot2c_f32_bf16_dpp v26, v17, v41 quad_perm:[2,2,2,2] row_mask:0xf bank_mask:0xf
    v_dot2c_f32_bf16_dpp v27, v16, v41 quad_perm:[2,2,2,2] row_mask:0xf bank_mask:0xf
    v_dot2c_f32_bf16_dpp v28, v17, v42 quad_perm:[2,2,2,2] row_mask:0xf bank_mask:0xf
    v_dot2c_f32_bf16_dpp v29, v16, v42 quad_perm:[2,2,2,2] row_mask:0xf bank_mask:0xf
    v_dot2c_f32_bf16_dpp v30, v17, v43 quad_perm:[2,2,2,2] row_mask:0xf bank_mask:0xf
    v_dot2c_f32_bf16_dpp v31, v16, v43 quad_perm:[2,2,2,2] row_mask:0xf bank_mask:0xf
    s_waitcnt lgkmcnt(0)
    ds_write_b32 v6, v9 offset:32
    v_dot2c_f32_bf16_dpp v24, v17, v44 quad_perm:[3,3,3,3] row_mask:0xf bank_mask:0xf
    v_dot2c_f32_bf16_dpp v25, v16, v44 quad_perm:[3,3,3,3] row_mask:0xf bank_mask:0xf
    v_dot2c_f32_bf16_dpp v26, v17, v45 quad_perm:[3,3,3,3] row_mask:0xf bank_mask:0xf
    v_dot2c_f32_bf16_dpp v27, v16, v45 quad_perm:[3,3,3,3] row_mask:0xf bank_mask:0xf
    v_dot2c_f32_bf16_dpp v28, v17, v46 quad_perm:[3,3,3,3] row_mask:0xf bank_mask:0xf
    v_dot2c_f32_bf16_dpp v29, v16, v46 quad_perm:[3,3,3,3] row_mask:0xf bank_mask:0xf
    v_dot2c_f32_bf16_dpp v30, v17, v47 quad_perm:[3,3,3,3] row_mask:0xf bank_mask:0xf
    v_dot2c_f32_bf16_dpp v31, v16, v47 quad_perm:[3,3,3,3] row_mask:0xf bank_mask:0xf
    s_cbranch_scc1 L_vc
    s_nop 1
    v_permlane32_swap_b32 v24, v28
    v_permlane32_swap_b32 v25, v29
    v_permlane32_swap_b32 v26, v30
    v_permlane32_swap_b32 v27, v31
    v_pk_add_f32 v[24:25], v[24:25], v[28:29]
    v_pk_add_f32 v[26:27], v[26:27], v[30:31]
    s_nop 1
    v_permlane16_swap_b32 v24, v26
    v_permlane16_swap_b32 v25, v27
    v_pk_add_f32 v[24:25], v[24:25], v[26:27]
    ds_write_b64 v15, v[24:25]
    s_waitcnt lgkmcnt(0)
    s_barrier
L_tailb:
    ds_read_b64 v[32:33], v14 offset:0
    ds_read_b64 v[34:35], v14 offset:528
    ds_read_b64 v[36:37], v14 offset:1056
    ds_read_b64 v[38:39], v14 offset:1584
    ds_read_b64 v[40:41], v14 offset:2112
    ds_read_b64 v[42:43], v14 offset:2640
    ds_read_b64 v[44:45], v14 offset:3168
    ds_read_b64 v[46:47], v14 offset:3696
    s_waitcnt lgkmcnt(4)
    v_pk_add_f32 v[32:33], v[32:33], v[36:37]
    v_pk_add_f32 v[34:35], v[34:35], v[38:39]
    v_pk_add_f32 v[32:33], v[32:33], v[34:35]
    s_waitcnt lgkmcnt(0)
    v_pk_add_f32 v[40:41], v[40:41], v[44:45]
    v_pk_add_f32 v[42:43], v[42:43], v[46:47]
    v_pk_add_f32 v[40:41], v[40:41], v[42:43]
    v_pk_add_f32 v[32:33], v[32:33], v[40:41]
    v_cvt_pk_bf16_f32 v32, v32, v33
    s_nop 1
    v_dot2c_f32_bf16_dpp v48, v32, v64 row_newbcast:0 row_mask:0xf bank_mask:0xf
    v_dot2c_f32_bf16_dpp v50, v32, v66 row_newbcast:0 row_mask:0xf bank_mask:0xf
    v_dot2c_f32_bf16_dpp v51, v32, v65 row_newbcast:0 row_mask:0xf bank_mask:0xf
    v_dot2c_f32_bf16_dpp v52, v32, v67 row_newbcast:0 row_mask:0xf bank_mask:0xf
    v_dot2c_f32_bf16_dpp v48, v32, v68 row_newbcast:1 row_mask:0xf bank_mask:0xf
    v_dot2c_f32_bf16_dpp v50, v32, v70 row_newbcast:1 row_mask:0xf bank_mask:0xf
    v_dot2c_f32_bf16_dpp v51, v32, v69 row_newbcast:1 row_mask:0xf bank_mask:0xf
    v_dot2c_f32_bf16_dpp v52, v32, v71 row_newbcast:1 row_mask:0xf bank_mask:0xf
    v_dot2c_f32_bf16_dpp v48, v32, v72 row_newbcast:2 row_mask:0xf bank_mask:0xf
    v_dot2c_f32_bf16_dpp v50, v32, v74 row_newbcast:2 row_mask:0xf bank_mask:0xf
    v_dot2c_f32_bf16_dpp v51, v32, v73 row_newbcast:2 row_mask:0xf bank_mask:0xf
    v_dot2c_f32_bf16_dpp v52, v32, v75 row_newbcast:2 row_mask:0xf bank_mask:0xf
    v_dot2c_f32_bf16_dpp v48, v32, v76 row_newbcast:3 row_mask:0xf bank_mask:0xf
    v_dot2c_f32_bf16_dpp v50, v32, v78 row_newbcast:3 row_mask:0xf bank_mask:0xf
    v_dot2c_f32_bf16_dpp v51, v32, v77 row_newbcast:3 row_mask:0xf bank_mask:0xf
    v_dot2c_f32_bf16_dpp v52, v32, v79 row_newbcast:3 row_mask:0xf bank_mask:0xf
    v_dot2c_f32_bf16_dpp v48, v32, v80 row_newbcast:4 row_mask:0xf bank_mask:0xf
    v_dot2c_f32_bf16_dpp v50, v32, v82 row_newbcast:4 row_mask:0xf bank_mask:0xf
    v_dot2c_f32_bf16_dpp v51, v32, v81 row_newbcast:4 row_mask:0xf bank_mask:0xf
    v_dot2c_f32_bf16_dpp v52, v32, v83 row_newbcast:4 row_mask:0xf bank_mask:0xf
    v_dot2c_f32_bf16_dpp v48, v32, v84 row_newbcast:5 row_mask:0xf bank_mask:0xf
    v_dot2c_f32_bf16_dpp v50, v32, v86 row_newbcast:5 row_mask:0xf bank_mask:0xf
    v_dot2c_f32_bf16_dpp v51, v32, v85 row_newbcast:5 row_mask:0xf bank_mask:0xf
    v_dot2c_f32_bf16_dpp v52, v32, v87 row_newbcast:5 row_mask:0xf bank_mask:0xf
    v_dot2c_f32_bf16_dpp v48, v32, v88 row_newbcast:6 row_mask:0xf bank_mask:0xf
    v_dot2c_f32_bf16_dpp v50, v32, v90 row_newbcast:6 row_mask:0xf bank_mask:0xf
    v_dot2c_f32_bf16_dpp v51, v32, v89 row_newbcast:6 row_mask:0xf bank_mask:0xf
    v_dot2c_f32_bf16_dpp v52, v32, v91 row_newbcast:6 row_mask:0xf bank_mask:0xf
    v_dot2c_f32_bf16_dpp v48, v32, v92 row_newbcast:7 row_mask:0xf bank_mask:0xf
    v_dot2c_f32_bf16_dpp v50, v32, v94 row_newbcast:7 row_mask:0xf bank_mask:0xf
    v_dot2c_f32_bf16_dpp v51, v32, v93 row_newbcast:7 row_mask:0xf bank_mask:0xf
    v_dot2c_f32_bf16_dpp v52, v32, v95 row_newbcast:7 row_mask:0xf bank_mask:0xf
    v_dot2c_f32_bf16_dpp v48, v32, v96 row_newbcast:8 row_mask:0xf bank_mask:0xf
    v_dot2c_f32_bf16_dpp v50, v32, v98 row_newbcast:8 row_mask:0xf bank_mask:0xf
    v_dot2c_f32_bf16_dpp v51, v32, v97 row_newbcast:8 row_mask:0xf bank_mask:0xf
    v_dot2c_f32_bf16_dpp v52, v32, v99 row_newbcast:8 row_mask:0xf bank_mask:0xf
    v_dot2c_f32_bf16_dpp v48, v32, v100 row_newbcast:9 row_mask:0xf bank_mask:0xf
    v_dot2c_f32_bf16_dpp v50, v32, v102 row_newbcast:9 row_mask:0xf bank_mask:0xf
    v_dot2c_f32_bf16_dpp v51, v32, v101 row_newbcast:9 row_mask:0xf bank_mask:0xf
    v_dot2c_f32_bf16_dpp v52, v32, v103 row_newbcast:9 row_mask:0xf bank_mask:0xf
    v_dot2c_f32_bf16_dpp v48, v32, v104 row_newbcast:10 row_mask:0xf bank_mask:0xf
    v_dot2c_f32_bf16_dpp v50, v32, v106 row_newbcast:10 row_mask:0xf bank_mask:0xf
    v_dot2c_f32_bf16_dpp v51, v32, v105 row_newbcast:10 row_mask:0xf bank_mask:0xf
    v_dot2c_f32_bf16_dpp v52, v32, v107 row_newbcast:10 row_mask:0xf bank_mask:0xf
    v_dot2c_f32_bf16_dpp v48, v32, v108 row_newbcast:11 row_mask:0xf bank_mask:0xf
    v_dot2c_f32_bf16_dpp v50, v32, v110 row_newbcast:11 row_mask:0xf bank_mask:0xf
    v_dot2c_f32_bf16_dpp v51, v32, v109 row_newbcast:11 row_mask:0xf bank_mask:0xf
    v_dot2c_f32_bf16_dpp v52, v32, v111 row_newbcast:11 row_mask:0xf bank_mask:0xf
    v_dot2c_f32_bf16_dpp v48, v32, v112 row_newbcast:12 row_mask:0xf bank_mask:0xf
    v_dot2c_f32_bf16_dpp v50, v32, v114 row_newbcast:12 row_mask:0xf bank_mask:0xf
    v_dot2c_f32_bf16_dpp v51, v32, v113 row_newbcast:12 row_mask:0xf bank_mask:0xf
    v_dot2c_f32_bf16_dpp v52, v32, v115 row_newbcast:12 row_mask:0xf bank_mask:0xf
    v_dot2c_f32_bf16_dpp v48, v32, v116 row_newbcast:13 row_mask:0xf bank_mask:0xf
    v_dot2c_f32_bf16_dpp v50, v32, v118 row_newbcast:13 row_mask:0xf bank_mask:0xf
    v_dot2c_f32_bf16_dpp v51, v32, v117 row_newbcast:13 row_mask:0xf bank_mask:0xf
    v_dot2c_f32_bf16_dpp v52, v32, v119 row_newbcast:13 row_mask:0xf bank_mask:0xf
    v_dot2c_f32_bf16_dpp v48, v32, v120 row_newbcast:14 row_mask:0xf bank_mask:0xf
    v_dot2c_f32_bf16_dpp v50, v32, v122 row_newbcast:14 row_mask:0xf bank_mask:0xf
    v_dot2c_f32_bf16_dpp v51, v32, v121 row_newbcast:14 row_mask:0xf bank_mask:0xf
    v_dot2c_f32_bf16_dpp v52, v32, v123 row_newbcast:14 row_mask:0xf bank_mask:0xf
    v_dot2c_f32_bf16_dpp v48, v32, v124 row_newbcast:15 row_mask:0xf bank_mask:0xf
    v_dot2c_f32_bf16_dpp v50, v32, v126 row_newbcast:15 row_mask:0xf bank_mask:0xf
    v_dot2c_f32_bf16_dpp v51, v32, v125 row_newbcast:15 row_mask:0xf bank_mask:0xf
    v_dot2c_f32_bf16_dpp v52, v32, v127 row_newbcast:15 row_mask:0xf bank_mask:0xf
    s_nop 1
    v_permlane32_swap_b32 v48, v51
    v_permlane32_swap_b32 v50, v52
    v_add_f32 v48, v48, v51
    v_add_f32 v50, v50, v52
    s_nop 1
    v_permlane16_swap_b32 v48, v50
    v_add_f32 v48, v48, v50
    s_cbranch_execz L_drain
    buffer_store_dwordx2 v[48:49], v13, s[56:59], 0 offen sc1
L_fin:
L_end:
    s_endpgm
.section .rodata,"a"
.p2align 6
.amdhsa_kernel parallel_sum__mha_block_cached__mixer_token_mlp__decode_kernel
  .amdhsa_next_free_vgpr 168
  .amdhsa_next_free_sgpr 96
  .amdhsa_accum_offset 168
  .amdhsa_group_segment_fixed_size 0
  .amdhsa_kernarg_size 104
  .amdhsa_user_sgpr_count 2
  .amdhsa_user_sgpr_kernarg_segment_ptr 1
  .amdhsa_system_sgpr_workgroup_id_x 1
  .amdhsa_float_denorm_mode_32 3
.end_amdhsa_kernel
```
